```python
import torch

def _softmax(x, axis=-1):
    return torch.softmax(x, dim=axis)
def _gelu(x):
    return torch.nn.functional.gelu(x, approximate="tanh")
def _silu(x):
    return torch.nn.functional.silu(x)
def _sigmoid(x):
    return torch.sigmoid(x)
def _layernorm(x, axis=-1, eps=1e-5):
    m = x.mean(dim=axis, keepdim=True)
    v = x.var(dim=axis, keepdim=True, unbiased=False)
    return (x - m) / torch.sqrt(v + eps)
def _scatter_add(tgt, idx, src, axis=0):
    return tgt.clone().index_add_(axis, idx, src)
def _segment_sum(src, seg, n):
    out = torch.zeros((n,) + src.shape[1:], dtype=src.dtype)
    return out.index_add_(0, seg, src)
def _pad(x, pw):
    flat = tuple(v for pair in reversed(pw) for v in pair)
    return torch.nn.functional.pad(x, flat)

kernel_name = 'parallel_sum__mha_block_cached__geglu_ffn__decode'

def setup_inputs():

    _w = (lambda a: (lambda t: t.to(torch.bfloat16) if t.is_floating_point() else t)(torch.as_tensor(a)))
    def _A_setup():
        B, Sq, D = 2, 1, 512
        H, Sk, Dh = 32, 4096, 128
        return {
            "x": _w((lambda *s: torch.randn(*s, dtype=torch.bfloat16) * 0.05)(B, Sq, D)),
            "k_cache": _w((lambda *s: torch.randn(*s, dtype=torch.bfloat16) * 3.2)(B, H, Sk, Dh)),
            "v_cache": _w((lambda *s: torch.randn(*s, dtype=torch.bfloat16) * 1.6)(B, H, Sk, Dh)),
            "wq": _w((lambda *s: torch.randn(*s, dtype=torch.bfloat16) * 3.2)(D, H * Dh) * (D ** -0.5)),
            "wo": _w((lambda *s: torch.randn(*s, dtype=torch.bfloat16) * 1.6)(H * Dh, D) * ((H * Dh) ** -0.5)),
        }
    _A_in = _A_setup()

    def _B_setup():
        B, S, D, F = 2, 1, 512, 1376
        return {
            "x": _w((lambda *s: torch.randn(*s, dtype=torch.bfloat16) * 0.05)(B, S, D)),
            "w_gate": _w((lambda *s: torch.randn(*s, dtype=torch.bfloat16) * 0.05)(D, F)),
            "w_up": _w((lambda *s: torch.randn(*s, dtype=torch.bfloat16) * 0.05)(D, F)),
            "w_down": _w((lambda *s: torch.randn(*s, dtype=torch.bfloat16) * 0.05)(F, D)),
        }
    _B_in = _B_setup()

    return {
        "A_x": _A_in["x"],
        "A_k_cache": _A_in["k_cache"],
        "A_v_cache": _A_in["v_cache"],
        "A_wq": _A_in["wq"],
        "A_wo": _A_in["wo"],
        "B_x": _B_in["x"],
        "B_w_gate": _B_in["w_gate"],
        "B_w_up": _B_in["w_up"],
        "B_w_down": _B_in["w_down"],
    }

def reference(A_x, A_k_cache, A_v_cache, A_wq, A_wo, B_x, B_w_gate, B_w_up, B_w_down):
    def _A_ref(x, k_cache, v_cache, wq, wo):
        B, Sq, D = x.shape
        H, Dh = 32, 128
        q = (lambda x, *d: x.permute(*d))((x @ wq).reshape(B, Sq, H, Dh), 0, 2, 1, 3)
        scores = torch.einsum("bhqd,bhkd->bhqk", q, k_cache) * (Dh ** -0.5)
        p = _softmax(scores, axis=-1)
        o = torch.einsum("bhqk,bhkd->bhqd", p, v_cache)
        return (lambda x, *d: x.permute(*d))(o, 0, 2, 1, 3).reshape(B, Sq, H * Dh) @ wo

    def _B_ref(x, w_gate, w_up, w_down):
        return (_gelu(x @ w_gate) * (x @ w_up)) @ w_down

    x = A_x
    xn = _layernorm(x, axis=-1)
    return x + _A_ref(xn, A_k_cache, A_v_cache, A_wq, A_wo) + _B_ref(xn, B_w_gate, B_w_up, B_w_down)
```

```asm
; @launch grid=(256,1,1) block=(512,1,1) lds=160000
.amdgcn_target "amdgcn-amd-amdhsa--gfx950"
.text
.globl parallel_sum__mha_block_cached__geglu_ffn__decode_kernel
.p2align 8
.type parallel_sum__mha_block_cached__geglu_ffn__decode_kernel,@function
parallel_sum__mha_block_cached__geglu_ffn__decode_kernel:
  s_cmp_ge_u32 s2, 256
  s_cbranch_scc1 L_end
  s_load_dwordx16 s[16:31], s[0:1], 0
  s_load_dwordx8 s[32:39], s[0:1], 64
  s_setprio 3
  v_lshrrev_b32 v1, 6, v0
  v_and_b32 v0, 63, v0
  v_mov_b32 v16, 0
  v_mov_b32 v17, 0
  v_mov_b32 v18, 0
  v_mov_b32 v19, 0
  v_readfirstlane_b32 s10, v1
  v_lshlrev_b32 v20, 4, v0
  ds_write_b128 v20, v[16:19] offset:8192
  s_and_b32 s3, s2, 7
  s_lshr_b32 s13, s2, 6
  s_bfe_u32 s12, s2, 0x30003
  s_lshr_b32 s8, s12, 2
  s_and_b32 s7, s12, 3
  s_lshl_b32 s6, s3, 2
  s_add_u32 s6, s6, s13
  s_lshl_b32 s11, s8, 5
  s_add_u32 s11, s11, s6
  s_and_b32 s9, s10, 3
  v_lshrrev_b32 v9, 4, v0
  v_lshrrev_b32 v10, 5, v0
  v_bfe_u32 v3, v0, 3, 1
  v_and_b32 v11, 1, v9
  v_and_b32 v6, 7, v0
  s_mul_i32 s96, s10, 18432
  s_add_u32 s96, s96, 12544
  s_mov_b32 s98, 0x5f0d5fdf
  s_bfm_b32 s99, s6, 0
  s_and_b32 s99, s99, s98
  s_bcnt1_i32_b32 s14, s99
  s_bitcmp1_b32 s98, s6
  s_cselect_b32 s15, 1, 0
  s_cselect_b32 s14, s14, 0
  s_lshl2_add_u32 s14, s14, s7
  s_cmp_lt_u32 s14, 86
  s_cselect_b32 s15, s15, 0
  s_cselect_b32 s14, s14, 0
  s_lshr_b32 s4, s14, 1
  s_lshl_b32 s4, s4, 3
  s_and_b32 s5, s14, 1
  s_add_u32 s4, s4, s5
  s_lshl_b32 s68, s4, 12
  s_mul_i32 s70, s15, 28672
  s_mov_b32 s71, 0x20000
  v_lshlrev_b32 v7, 1, v9
  v_xor_b32 v7, v6, v7
  s_lshl_b32 s4, s10, 7
  v_lshl_add_u32 v7, v7, 4, s4
  s_lshl_b32 s56, s6, 17
  s_mov_b32 s58, 131072
  s_mov_b32 s59, 0x20000
  s_lshr_b32 s4, s12, 1
  s_and_b32 s5, s12, 1
  s_lshl_b32 s97, s4, 3
  s_add_u32 s97, s97, s5
  s_lshl_b32 s97, s97, 12
  s_lshl_b32 s4, s4, 2
  s_add_u32 s4, s4, s5
  s_lshl_b32 s4, s4, 10
  s_add_u32 m0, s4, s96
  v_lshl_add_u32 v110, v9, 13, v7
  v_lshl_add_u32 v110, v3, 11, v110
  v_add_u32 v110, s97, v110
  v_lshl_add_u32 v111, v9, 10, v7
  v_lshl_add_u32 v111, v3, 13, v111
  s_lshr_b32 s4, s10, 2
  s_xor_b32 s4, s4, s8
  s_lshl_b32 s4, s4, 17
  s_lshl_b32 s5, s9, 12
  s_add_u32 s78, s4, s5
  v_lshl_add_u32 v1, v6, 4, s78
  v_lshl_add_u32 v1, v11, 7, v1
  v_lshl_add_u32 v1, v3, 8, v1
  v_lshl_add_u32 v1, v10, 9, v1
  s_lshl_b32 s100, s11, 20
  s_lshl_b32 s101, s7, 18
  s_add_u32 s100, s100, s101
  v_lshlrev_b32 v14, 5, v0
  s_lshl_b32 s4, s9, 5
  v_lshl_add_u32 v5, v9, 3, s4
  v_add_lshl_u32 v4, v5, v3, 13
  v_lshl_add_u32 v4, v6, 4, v4
  s_lshl_b32 s98, s7, 20
  s_lshl_b32 s99, s6, 8
  s_add_u32 s98, s98, s99
  s_lshl_b32 s99, s8, 7
  s_add_u32 s98, s98, s99
  s_sub_u32 s99, 0x400000, s98
  s_mov_b32 s4, 16384
  s_mov_b32 s5, 32768
  s_mov_b32 s14, 49152
  s_mov_b32 s46, 262144
  s_mov_b32 s47, 0x20000
  s_mov_b32 s42, 2048
  s_mov_b32 s43, 0x20000
  s_mov_b32 s54, s99
  s_mov_b32 s55, 0x20000
  s_waitcnt lgkmcnt(0)
  s_add_u32 s44, s18, s100
  s_addc_u32 s45, s19, 0
  s_mov_b32 s40, s16
  s_mov_b32 s41, s17
  s_add_u32 s56, s24, s56
  s_addc_u32 s57, s25, 0
  s_add_u32 s68, s32, s68
  s_addc_u32 s69, s33, 0
  s_cmp_lt_u32 s10, 4
  s_cbranch_scc1 L_w0
  buffer_load_dwordx4 v[40:43], v14, s[40:43], 0 offen
  buffer_load_dwordx4 v[44:47], v14, s[40:43], 0 offen offset:16
  s_add_u32 s52, s22, s98
  s_addc_u32 s53, s23, 0
  buffer_load_dwordx4 v[64:67], v4, s[52:55], 0 offen nt
  buffer_load_dwordx4 v[68:71], v4, s[52:55], s4 offen nt
  buffer_load_dwordx4 v[72:75], v4, s[52:55], s5 offen nt
  buffer_load_dwordx4 v[76:79], v4, s[52:55], s14 offen nt
  s_load_dword s77, s[38:39], 0
L_w0:
  buffer_load_dwordx4 v110, s[56:59], 0 offen  lds
  s_add_u32 m0, m0, 1024
  s_nop 0
  buffer_load_dwordx4 v110, s[56:59], 0 offen offset:1024  lds
  s_add_u32 m0, s96, 16384
  s_nop 0
  buffer_load_dwordx4 v111, s[68:71], 0 offen  lds
  s_add_u32 m0, s96, 17408
  s_nop 0
  buffer_load_dwordx4 v111, s[68:71], s4 offen  lds
  s_cmp_lt_u32 s10, 4
  s_cbranch_scc1 L_burst
  s_barrier
  s_branch L_pro
L_burst:
  s_setprio 1
  buffer_load_dwordx4 v[128:131], v1, s[44:47], 0 offen offset:0 nt
  buffer_load_dwordx4 v[132:135], v1, s[44:47], 0 offen offset:1024 nt
  buffer_load_dwordx4 v[136:139], v1, s[44:47], 0 offen offset:2048 nt
  buffer_load_dwordx4 v[140:143], v1, s[44:47], 0 offen offset:3072 nt
  s_cmp_lt_u32 s10, 4
  s_cbranch_scc0 L_sk_kb
  s_barrier
L_sk_kb:
  s_mov_b32 s27, 16384
  buffer_load_dwordx4 v[144:147], v1, s[44:47], s27 offen offset:0 nt
  buffer_load_dwordx4 v[148:151], v1, s[44:47], s27 offen offset:1024 nt
  buffer_load_dwordx4 v[152:155], v1, s[44:47], s27 offen offset:2048 nt
  buffer_load_dwordx4 v[156:159], v1, s[44:47], s27 offen offset:3072 nt
  s_mov_b32 s27, 32768
  buffer_load_dwordx4 v[160:163], v1, s[44:47], s27 offen offset:0 nt
  buffer_load_dwordx4 v[164:167], v1, s[44:47], s27 offen offset:1024 nt
  buffer_load_dwordx4 v[168:171], v1, s[44:47], s27 offen offset:2048 nt
  buffer_load_dwordx4 v[172:175], v1, s[44:47], s27 offen offset:3072 nt
  s_mov_b32 s27, 49152
  buffer_load_dwordx4 v[176:179], v1, s[44:47], s27 offen offset:0 nt
  buffer_load_dwordx4 v[180:183], v1, s[44:47], s27 offen offset:1024 nt
  buffer_load_dwordx4 v[184:187], v1, s[44:47], s27 offen offset:2048 nt
  buffer_load_dwordx4 v[188:191], v1, s[44:47], s27 offen offset:3072 nt
  s_mov_b32 s98, 0x5f0d5fdf
  s_bfm_b32 s99, s6, 0
  s_and_b32 s99, s99, s98
  s_bcnt1_i32_b32 s14, s99
  s_bitcmp1_b32 s98, s6
  s_cselect_b32 s15, 1, 0
  s_cselect_b32 s14, s14, 0
  s_lshl2_add_u32 s14, s14, s7
  s_cmp_lt_u32 s14, 86
  s_cselect_b32 s15, s15, 0
  s_cselect_b32 s14, s14, 0
  s_cmp_eq_u32 s10, 1
  s_cselect_b32 s79, s15, 0
  s_mov_b32 s72, s38
  s_mov_b32 s73, s39
  s_mov_b32 s74, 268435456
  s_mov_b32 s75, 0x20000
  s_add_u32 s48, s20, s100
  s_addc_u32 s49, s21, 0
  s_mov_b32 s50, 262144
  s_mov_b32 s51, 0x20000
  s_mov_b32 s80, s34
  s_mov_b32 s81, s35
  s_mov_b32 s82, 2048
  s_mov_b32 s83, 0x20000
  s_lshr_b32 s4, s12, 1
  s_and_b32 s5, s12, 1
  s_lshl_b32 s97, s4, 15
  s_lshl_b32 s98, s4, 12
  s_lshl_b32 s4, s5, 12
  s_or_b32 s97, s97, s4
  s_lshl_b32 s4, s5, 10
  s_or_b32 s98, s98, s4
  v_and_b32 v8, 15, v0
  v_and_b32 v12, 3, v0
  v_and_b32 v15, 31, v0
  v_lshl_add_u32 v2, v8, 4, s78
  v_lshl_add_u32 v2, v10, 8, v2
  v_lshl_add_u32 v2, v11, 11, v2
  v_lshlrev_b32 v7, 1, v9
  v_xor_b32 v7, v6, v7
  s_lshl_b32 s4, s10, 7
  v_lshl_add_u32 v7, v7, 4, s4
  v_lshl_add_u32 v4, v9, 13, v7
  v_lshl_add_u32 v4, v3, 11, v4
  s_cmp_eq_u32 s2, 0
  s_cbranch_scc0 L_sk_az
  s_mul_i32 s4, s10, 2048
  s_add_u32 s4, s4, 524288
  v_lshrrev_b32 v17, 3, v0
  v_mul_u32_u24 v17, 128, v17
  v_lshl_add_u32 v17, v6, 4, v17
  v_add_u32 v17, s4, v17
  v_add_u32 v18, 1024, v17
  v_mov_b32 v20, 0
  v_mov_b32 v21, 0
  v_mov_b32 v22, 0
  v_mov_b32 v23, 0
  buffer_store_dwordx4 v[20:23], v17, s[72:75], 0 offen sc1
  buffer_store_dwordx4 v[20:23], v18, s[72:75], 0 offen sc1
  s_nop 1
L_sk_az:
  s_lshl_b32 s4, s6, 12
  s_lshl_b32 s5, s8, 8
  s_add_u32 s4, s4, s5
  s_add_u32 s4, s4, 131072
  v_lshl_add_u32 v13, v8, 4, s4
  v_lshl_add_u32 v13, v9, 9, v13
  s_mov_b32 s27, 65536
  buffer_load_dwordx4 v[192:195], v1, s[44:47], s27 offen offset:0 nt
  buffer_load_dwordx4 v[196:199], v1, s[44:47], s27 offen offset:1024 nt
  buffer_load_dwordx4 v[200:203], v1, s[44:47], s27 offen offset:2048 nt
  buffer_load_dwordx4 v[204:207], v1, s[44:47], s27 offen offset:3072 nt
  s_mov_b32 s27, 81920
  buffer_load_dwordx4 v[208:211], v1, s[44:47], s27 offen offset:0 nt
  buffer_load_dwordx4 v[212:215], v1, s[44:47], s27 offen offset:1024 nt
  buffer_load_dwordx4 v[216:219], v1, s[44:47], s27 offen offset:2048 nt
  buffer_load_dwordx4 v[220:223], v1, s[44:47], s27 offen offset:3072 nt
  s_mov_b32 s27, 98304
  buffer_load_dwordx4 v[224:227], v1, s[44:47], s27 offen offset:0 nt
  buffer_load_dwordx4 v[228:231], v1, s[44:47], s27 offen offset:1024 nt
  buffer_load_dwordx4 v[232:235], v1, s[44:47], s27 offen offset:2048 nt
  buffer_load_dwordx4 v[236:239], v1, s[44:47], s27 offen offset:3072 nt
  s_mov_b32 s27, 114688
  buffer_load_dwordx4 v[240:243], v1, s[44:47], s27 offen offset:0 nt
  buffer_load_dwordx4 v[244:247], v1, s[44:47], s27 offen offset:1024 nt
  buffer_load_dwordx4 v[248:251], v1, s[44:47], s27 offen offset:2048 nt
  buffer_load_dwordx4 v[252:255], v1, s[44:47], s27 offen offset:3072 nt
  s_cmp_eq_u32 s10, 0
  s_cbranch_scc0 L_sk_qg
  buffer_load_dwordx4 v[112:115], v13, s[72:75], 0 offen offset:0 sc1
  buffer_load_dwordx4 v[116:119], v13, s[72:75], 0 offen offset:2048 sc1
L_sk_qg:
  s_setprio 3
  v_mov_b32 v16, 0
  s_mov_b32 s101, 0
L_tg:
  ds_read_b32 v17, v16 offset:8208
  s_add_u32 s101, s101, 1
  s_cmp_ge_u32 s101, 0x40000
  s_cbranch_scc1 L_tg_ok
  s_waitcnt lgkmcnt(0)
  v_readfirstlane_b32 s4, v17
  s_nop 0
  s_cmp_lt_u32 s4, 65536
  s_cbranch_scc0 L_tg_ok
  s_sleep 1
  s_branch L_tg
L_tg_ok:
  s_and_b32 s76, s4, 0xffff
  s_and_b32 s24, s76, 3
  s_and_b32 s25, s76, 63
  s_lshl_b32 s99, s11, 2
  s_add_u32 s99, s99, s7
  s_lshl_b32 s99, s99, 7
  s_lshl_b32 s100, s10, 4
  s_add_u32 s99, s99, s100
  s_add_u32 s99, s99, 65536
  s_mov_b32 s16, 0x0f0ff0f0
  s_mov_b32 s17, 0x0f0ff0f0
  v_lshl_add_u32 v61, v11, 3, v6
  v_lshl_add_u32 v61, v61, 4, 64
  v_add_u32 v61, 64, v61
  v_cmp_eq_u32 vcc, v10, v3
  s_nop 1
  v_cndmask_b32 v61, 0, v61, vcc
  v_xor_b32 v62, 64, v61
  v_lshlrev_b32 v18, 2, v12
  v_lshl_add_u32 v18, v3, 4, v18
  v_lshl_add_u32 v18, v11, 5, v18
  v_bfe_u32 v19, v0, 2, 1
  v_lshl_add_u32 v18, v19, 6, v18
  v_lshl_add_u32 v18, v10, 7, v18
  v_lshlrev_b32 v120, 1, v12
  v_lshl_add_u32 v120, v10, 3, v120
  v_lshl_add_u32 v120, v11, 4, v120
  v_mul_u32_u24 v14, 288, v6
  v_lshl_add_u32 v14, v9, 4, v14
  v_lshl_add_u32 v14, v3, 10, v14
  v_lshlrev_b32 v6, 2, v6
  v_lshl_add_u32 v6, v9, 5, v6
  s_mul_i32 s100, s10, 288
  s_add_u32 s100, s100, 9216
  v_add_u32 v6, s100, v6
  v_bfe_u32 v3, v0, 2, 2
  v_mul_u32_u24 v3, 288, v3
  v_lshl_add_u32 v3, v12, 3, v3
  v_lshl_add_u32 v3, v10, 10, v3
  v_lshl_add_u32 v3, v11, 7, v3
  v_add_u32 v3, s96, v3
  s_lshl3_add_u32 s100, s8, s10
  s_mul_i32 s100, s100, 1024
  s_add_u32 s100, s100, 524288
  v_lshrrev_b32 v7, 3, v0
  v_mul_u32_u24 v7, 128, v7
  v_and_b32 v8, 7, v0
  v_lshl_add_u32 v7, v8, 3, v7
  v_add_u32 v7, s100, v7
  v_mov_b32 v12, v9
  v_and_b32 v32, 1, v0
  v_lshlrev_b32 v32, 4, v32
  v_mov_b32 v33, 0xffff
  v_lshlrev_b32 v33, v32, v33
  v_bfe_u32 v35, v0, 1, 2
  v_cmp_eq_u32 vcc, 0, v35
  s_nop 1
  v_cndmask_b32 v8, 0, v33, vcc
  v_cmp_eq_u32 vcc, 1, v35
  s_nop 1
  v_cndmask_b32 v9, 0, v33, vcc
  v_cmp_eq_u32 vcc, 2, v35
  s_nop 1
  v_cndmask_b32 v10, 0, v33, vcc
  v_cmp_eq_u32 vcc, 3, v35
  s_nop 1
  v_cndmask_b32 v11, 0, v33, vcc
  v_mov_b32 v16, 0
  v_mov_b32 v19, 1
  v_mov_b32 v63, 0xff
  s_mov_b32 s26, 0x3db504f3
  s_cmp_eq_u32 s10, 0
  s_cbranch_scc0 L_sk_qw
  s_waitcnt vmcnt(0)
  v_xor_b32 v112, s24, v112
  v_xor_b32 v113, s24, v113
  v_xor_b32 v114, s24, v114
  v_xor_b32 v115, s24, v115
  v_xor_b32 v116, s24, v116
  v_xor_b32 v117, s24, v117
  v_xor_b32 v118, s24, v118
  v_xor_b32 v119, s24, v119
  v_or3_b32 v20, v112, v113, v114
  v_or3_b32 v21, v116, v117, v118
  v_or3_b32 v20, v20, v21, v119
  v_or_b32 v20, v20, v115
  v_and_b32 v21, 3, v20
  v_cmp_ne_u32 vcc, 0, v21
  s_nop 4
  s_cbranch_vccz L_qg_ok
  s_mov_b32 s101, 0
L_qg_poll:
  s_sleep 8
  s_cmp_lt_u32 s101, 4
  s_cbranch_scc1 L_qg_ld
  buffer_inv sc1
  s_waitcnt vmcnt(0)
L_qg_ld:
  buffer_load_dwordx4 v[112:115], v13, s[72:75], 0 offen offset:0 sc1
  buffer_load_dwordx4 v[116:119], v13, s[72:75], 0 offen offset:2048 sc1
  s_waitcnt vmcnt(0)
  v_xor_b32 v112, s24, v112
  v_xor_b32 v113, s24, v113
  v_xor_b32 v114, s24, v114
  v_xor_b32 v115, s24, v115
  v_xor_b32 v116, s24, v116
  v_xor_b32 v117, s24, v117
  v_xor_b32 v118, s24, v118
  v_xor_b32 v119, s24, v119
  v_or3_b32 v20, v112, v113, v114
  v_or3_b32 v21, v116, v117, v118
  v_or3_b32 v20, v20, v21, v119
  v_or_b32 v20, v20, v115
  v_and_b32 v21, 3, v20
  v_cmp_ne_u32 vcc, 0, v21
  s_add_u32 s101, s101, 1
  s_cmp_ge_u32 s101, 0x4000
  s_cbranch_scc1 L_qg_ok
  s_nop 4
  s_cbranch_vccnz L_qg_poll
L_qg_ok:
  s_nop 1
  v_and_b32 v112, -8, v112
  v_and_b32 v113, -8, v113
  v_and_b32 v114, -8, v114
  v_and_b32 v115, -8, v115
  v_and_b32 v116, -8, v116
  v_and_b32 v117, -8, v117
  v_and_b32 v118, -8, v118
  v_and_b32 v119, -8, v119
  v_permlane32_swap_b32 v112, v116
  v_permlane32_swap_b32 v113, v117
  v_permlane32_swap_b32 v114, v118
  v_permlane32_swap_b32 v115, v119
  v_add_f32 v112, v112, v116
  v_add_f32 v113, v113, v117
  v_add_f32 v114, v114, v118
  v_add_f32 v115, v115, v119
  v_permlane16_swap_b32 v112, v113
  s_nop 0
  v_permlane16_swap_b32 v114, v115
  v_add_f32 v112, v112, v113
  v_add_f32 v114, v114, v115
  v_cvt_pk_bf16_f32 v112, v112, v114
  ds_write_b32 v18, v112 offset:8448
  v_and_b32 v20, 4, v20
  v_cmp_ne_u32 vcc, 0, v20
  s_nop 0
  s_cmp_lg_u64 vcc, 0
  s_cselect_b32 s4, 0x101, 1
  v_mov_b32 v19, s4
  s_waitcnt lgkmcnt(0)
  s_mov_b64 exec, 1
  ds_add_u32 v16, v19 offset:8200
  s_mov_b64 exec, -1
L_sk_qw:
  s_mov_b32 s101, 0
L_qs:
  ds_read_b32 v17, v16 offset:8200
  s_add_u32 s101, s101, 1
  s_cmp_ge_u32 s101, 0x40000
  s_cbranch_scc1 L_qs_ok
  s_waitcnt lgkmcnt(0)
  v_readfirstlane_b32 s4, v17
  s_nop 0
  s_cmp_lt_u32 s4, 1
  s_cbranch_scc0 L_qs_ok
  s_sleep 1
  s_branch L_qs
L_qs_ok:
  s_mov_b32 s24, s4
  ds_read_b128 v[40:43], v61 offset:8320
  ds_read_b128 v[44:47], v62 offset:8320
  s_bitcmp1_b32 s24, 8
  s_cbranch_scc1 L_far_q
L_back_q:
  s_waitcnt lgkmcnt(0)
  s_waitcnt vmcnt(31)
  v_mfma_f32_16x16x32_bf16 v[64:67], v[128:131], v[40:43], 0
  s_waitcnt vmcnt(30)
  v_mfma_f32_16x16x32_bf16 v[68:71], v[132:135], v[44:47], 0
  s_waitcnt vmcnt(29)
  v_mfma_f32_16x16x32_bf16 v[72:75], v[136:139], v[40:43], 0
  s_waitcnt vmcnt(28)
  v_mfma_f32_16x16x32_bf16 v[76:79], v[140:143], v[44:47], 0
  s_nop 3
  v_cndmask_b32 v64, v64, v68, s[16:17]
  v_cndmask_b32 v65, v65, v69, s[16:17]
  v_cndmask_b32 v66, v66, v70, s[16:17]
  v_cndmask_b32 v67, v67, v71, s[16:17]
  v_mov_b32_dpp v32, v64 quad_perm:[0,0,0,0] row_mask:0xf bank_mask:0xf
  v_add_f32_dpp v32, v65, v32 quad_perm:[1,1,1,1] row_mask:0xf bank_mask:0xf
  v_add_f32_dpp v32, v66, v32 quad_perm:[2,2,2,2] row_mask:0xf bank_mask:0xf
  v_add_f32_dpp v32, v67, v32 quad_perm:[3,3,3,3] row_mask:0xf bank_mask:0xf
  s_waitcnt vmcnt(27)
  v_mfma_f32_16x16x32_bf16 v[80:83], v[144:147], v[40:43], 0
  v_cndmask_b32 v72, v72, v76, s[16:17]
  v_cndmask_b32 v73, v73, v77, s[16:17]
  v_cndmask_b32 v74, v74, v78, s[16:17]
  v_cndmask_b32 v75, v75, v79, s[16:17]
  v_mov_b32_dpp v24, v72 quad_perm:[0,0,0,0] row_mask:0xf bank_mask:0xf
  v_add_f32_dpp v24, v73, v24 quad_perm:[1,1,1,1] row_mask:0xf bank_mask:0xf
  v_add_f32_dpp v24, v74, v24 quad_perm:[2,2,2,2] row_mask:0xf bank_mask:0xf
  v_add_f32_dpp v24, v75, v24 quad_perm:[3,3,3,3] row_mask:0xf bank_mask:0xf
  s_waitcnt vmcnt(26)
  v_mfma_f32_16x16x32_bf16 v[84:87], v[148:151], v[44:47], 0
  v_permlane16_swap_b32 v32, v24
  s_nop 1
  v_add_f32_dpp v32, v24, v32 row_half_mirror row_mask:0xf bank_mask:0xf
  v_cvt_pk_bf16_f32 v32, v32, v32
  v_and_b32 v32, 0xffff0000, v32
  v_mul_f32 v32, s26, v32
  v_cvt_pk_bf16_f32 v32, v32, v32
  v_and_b32 v32, 0xffff0000, v32
  v_mov_b32 v60, v32
  s_waitcnt vmcnt(25)
  v_mfma_f32_16x16x32_bf16 v[88:91], v[152:155], v[40:43], 0
  s_waitcnt vmcnt(24)
  v_mfma_f32_16x16x32_bf16 v[92:95], v[156:159], v[44:47], 0
  v_cndmask_b32 v80, v80, v84, s[16:17]
  v_cndmask_b32 v81, v81, v85, s[16:17]
  v_cndmask_b32 v82, v82, v86, s[16:17]
  v_cndmask_b32 v83, v83, v87, s[16:17]
  v_mov_b32_dpp v33, v80 quad_perm:[0,0,0,0] row_mask:0xf bank_mask:0xf
  v_add_f32_dpp v33, v81, v33 quad_perm:[1,1,1,1] row_mask:0xf bank_mask:0xf
  v_add_f32_dpp v33, v82, v33 quad_perm:[2,2,2,2] row_mask:0xf bank_mask:0xf
  v_add_f32_dpp v33, v83, v33 quad_perm:[3,3,3,3] row_mask:0xf bank_mask:0xf
  s_waitcnt vmcnt(23)
  v_mfma_f32_16x16x32_bf16 v[64:67], v[160:163], v[40:43], 0
  v_cndmask_b32 v88, v88, v92, s[16:17]
  v_cndmask_b32 v89, v89, v93, s[16:17]
  v_cndmask_b32 v90, v90, v94, s[16:17]
  v_cndmask_b32 v91, v91, v95, s[16:17]
  v_mov_b32_dpp v24, v88 quad_perm:[0,0,0,0] row_mask:0xf bank_mask:0xf
  v_add_f32_dpp v24, v89, v24 quad_perm:[1,1,1,1] row_mask:0xf bank_mask:0xf
  v_add_f32_dpp v24, v90, v24 quad_perm:[2,2,2,2] row_mask:0xf bank_mask:0xf
  v_add_f32_dpp v24, v91, v24 quad_perm:[3,3,3,3] row_mask:0xf bank_mask:0xf
  s_waitcnt vmcnt(22)
  v_mfma_f32_16x16x32_bf16 v[68:71], v[164:167], v[44:47], 0
  v_permlane16_swap_b32 v33, v24
  s_nop 1
  v_add_f32_dpp v33, v24, v33 row_half_mirror row_mask:0xf bank_mask:0xf
  v_cvt_pk_bf16_f32 v33, v33, v33
  v_and_b32 v33, 0xffff0000, v33
  v_mul_f32 v33, s26, v33
  v_cvt_pk_bf16_f32 v33, v33, v33
  v_and_b32 v33, 0xffff0000, v33
  v_max_f32 v60, v60, v33
  s_waitcnt vmcnt(21)
  v_mfma_f32_16x16x32_bf16 v[72:75], v[168:171], v[40:43], 0
  s_waitcnt vmcnt(20)
  v_mfma_f32_16x16x32_bf16 v[76:79], v[172:175], v[44:47], 0
  v_cndmask_b32 v64, v64, v68, s[16:17]
  v_cndmask_b32 v65, v65, v69, s[16:17]
  v_cndmask_b32 v66, v66, v70, s[16:17]
  v_cndmask_b32 v67, v67, v71, s[16:17]
  v_mov_b32_dpp v34, v64 quad_perm:[0,0,0,0] row_mask:0xf bank_mask:0xf
  v_add_f32_dpp v34, v65, v34 quad_perm:[1,1,1,1] row_mask:0xf bank_mask:0xf
  v_add_f32_dpp v34, v66, v34 quad_perm:[2,2,2,2] row_mask:0xf bank_mask:0xf
  v_add_f32_dpp v34, v67, v34 quad_perm:[3,3,3,3] row_mask:0xf bank_mask:0xf
  s_waitcnt vmcnt(19)
  v_mfma_f32_16x16x32_bf16 v[80:83], v[176:179], v[40:43], 0
  v_cndmask_b32 v72, v72, v76, s[16:17]
  v_cndmask_b32 v73, v73, v77, s[16:17]
  v_cndmask_b32 v74, v74, v78, s[16:17]
  v_cndmask_b32 v75, v75, v79, s[16:17]
  v_mov_b32_dpp v24, v72 quad_perm:[0,0,0,0] row_mask:0xf bank_mask:0xf
  v_add_f32_dpp v24, v73, v24 quad_perm:[1,1,1,1] row_mask:0xf bank_mask:0xf
  v_add_f32_dpp v24, v74, v24 quad_perm:[2,2,2,2] row_mask:0xf bank_mask:0xf
  v_add_f32_dpp v24, v75, v24 quad_perm:[3,3,3,3] row_mask:0xf bank_mask:0xf
  s_waitcnt vmcnt(18)
  v_mfma_f32_16x16x32_bf16 v[84:87], v[180:183], v[44:47], 0
  v_permlane16_swap_b32 v34, v24
  s_nop 1
  v_add_f32_dpp v34, v24, v34 row_half_mirror row_mask:0xf bank_mask:0xf
  v_cvt_pk_bf16_f32 v34, v34, v34
  v_and_b32 v34, 0xffff0000, v34
  v_mul_f32 v34, s26, v34
  v_cvt_pk_bf16_f32 v34, v34, v34
  v_and_b32 v34, 0xffff0000, v34
  v_max_f32 v60, v60, v34
  s_waitcnt vmcnt(17)
  v_mfma_f32_16x16x32_bf16 v[88:91], v[184:187], v[40:43], 0
  s_waitcnt vmcnt(16)
  v_mfma_f32_16x16x32_bf16 v[92:95], v[188:191], v[44:47], 0
  v_cndmask_b32 v80, v80, v84, s[16:17]
  v_cndmask_b32 v81, v81, v85, s[16:17]
  v_cndmask_b32 v82, v82, v86, s[16:17]
  v_cndmask_b32 v83, v83, v87, s[16:17]
  v_mov_b32_dpp v35, v80 quad_perm:[0,0,0,0] row_mask:0xf bank_mask:0xf
  v_add_f32_dpp v35, v81, v35 quad_perm:[1,1,1,1] row_mask:0xf bank_mask:0xf
  v_add_f32_dpp v35, v82, v35 quad_perm:[2,2,2,2] row_mask:0xf bank_mask:0xf
  v_add_f32_dpp v35, v83, v35 quad_perm:[3,3,3,3] row_mask:0xf bank_mask:0xf
  s_waitcnt vmcnt(15)
  v_mfma_f32_16x16x32_bf16 v[64:67], v[192:195], v[40:43], 0
  v_cndmask_b32 v88, v88, v92, s[16:17]
  v_cndmask_b32 v89, v89, v93, s[16:17]
  v_cndmask_b32 v90, v90, v94, s[16:17]
  v_cndmask_b32 v91, v91, v95, s[16:17]
  v_mov_b32_dpp v24, v88 quad_perm:[0,0,0,0] row_mask:0xf bank_mask:0xf
  v_add_f32_dpp v24, v89, v24 quad_perm:[1,1,1,1] row_mask:0xf bank_mask:0xf
  v_add_f32_dpp v24, v90, v24 quad_perm:[2,2,2,2] row_mask:0xf bank_mask:0xf
  v_add_f32_dpp v24, v91, v24 quad_perm:[3,3,3,3] row_mask:0xf bank_mask:0xf
  s_waitcnt vmcnt(14)
  v_mfma_f32_16x16x32_bf16 v[68:71], v[196:199], v[44:47], 0
  v_permlane16_swap_b32 v35, v24
  s_nop 1
  v_add_f32_dpp v35, v24, v35 row_half_mirror row_mask:0xf bank_mask:0xf
  v_cvt_pk_bf16_f32 v35, v35, v35
  v_and_b32 v35, 0xffff0000, v35
  v_mul_f32 v35, s26, v35
  v_cvt_pk_bf16_f32 v35, v35, v35
  v_and_b32 v35, 0xffff0000, v35
  v_max_f32 v60, v60, v35
  s_waitcnt vmcnt(13)
  v_mfma_f32_16x16x32_bf16 v[72:75], v[200:203], v[40:43], 0
  s_waitcnt vmcnt(12)
  v_mfma_f32_16x16x32_bf16 v[76:79], v[204:207], v[44:47], 0
  v_cndmask_b32 v64, v64, v68, s[16:17]
  v_cndmask_b32 v65, v65, v69, s[16:17]
  v_cndmask_b32 v66, v66, v70, s[16:17]
  v_cndmask_b32 v67, v67, v71, s[16:17]
  v_mov_b32_dpp v36, v64 quad_perm:[0,0,0,0] row_mask:0xf bank_mask:0xf
  v_add_f32_dpp v36, v65, v36 quad_perm:[1,1,1,1] row_mask:0xf bank_mask:0xf
  v_add_f32_dpp v36, v66, v36 quad_perm:[2,2,2,2] row_mask:0xf bank_mask:0xf
  v_add_f32_dpp v36, v67, v36 quad_perm:[3,3,3,3] row_mask:0xf bank_mask:0xf
  s_waitcnt vmcnt(11)
  v_mfma_f32_16x16x32_bf16 v[80:83], v[208:211], v[40:43], 0
  v_cndmask_b32 v72, v72, v76, s[16:17]
  v_cndmask_b32 v73, v73, v77, s[16:17]
  v_cndmask_b32 v74, v74, v78, s[16:17]
  v_cndmask_b32 v75, v75, v79, s[16:17]
  v_mov_b32_dpp v24, v72 quad_perm:[0,0,0,0] row_mask:0xf bank_mask:0xf
  v_add_f32_dpp v24, v73, v24 quad_perm:[1,1,1,1] row_mask:0xf bank_mask:0xf
  v_add_f32_dpp v24, v74, v24 quad_perm:[2,2,2,2] row_mask:0xf bank_mask:0xf
  v_add_f32_dpp v24, v75, v24 quad_perm:[3,3,3,3] row_mask:0xf bank_mask:0xf
  s_waitcnt vmcnt(10)
  v_mfma_f32_16x16x32_bf16 v[84:87], v[212:215], v[44:47], 0
  v_permlane16_swap_b32 v36, v24
  s_nop 1
  v_add_f32_dpp v36, v24, v36 row_half_mirror row_mask:0xf bank_mask:0xf
  v_cvt_pk_bf16_f32 v36, v36, v36
  v_and_b32 v36, 0xffff0000, v36
  v_mul_f32 v36, s26, v36
  v_cvt_pk_bf16_f32 v36, v36, v36
  v_and_b32 v36, 0xffff0000, v36
  v_max_f32 v60, v60, v36
  s_waitcnt vmcnt(9)
  v_mfma_f32_16x16x32_bf16 v[88:91], v[216:219], v[40:43], 0
  s_waitcnt vmcnt(8)
  v_mfma_f32_16x16x32_bf16 v[92:95], v[220:223], v[44:47], 0
  v_cndmask_b32 v80, v80, v84, s[16:17]
  v_cndmask_b32 v81, v81, v85, s[16:17]
  v_cndmask_b32 v82, v82, v86, s[16:17]
  v_cndmask_b32 v83, v83, v87, s[16:17]
  v_mov_b32_dpp v37, v80 quad_perm:[0,0,0,0] row_mask:0xf bank_mask:0xf
  v_add_f32_dpp v37, v81, v37 quad_perm:[1,1,1,1] row_mask:0xf bank_mask:0xf
  v_add_f32_dpp v37, v82, v37 quad_perm:[2,2,2,2] row_mask:0xf bank_mask:0xf
  v_add_f32_dpp v37, v83, v37 quad_perm:[3,3,3,3] row_mask:0xf bank_mask:0xf
  s_waitcnt vmcnt(7)
  v_mfma_f32_16x16x32_bf16 v[64:67], v[224:227], v[40:43], 0
  v_cndmask_b32 v88, v88, v92, s[16:17]
  v_cndmask_b32 v89, v89, v93, s[16:17]
  v_cndmask_b32 v90, v90, v94, s[16:17]
  v_cndmask_b32 v91, v91, v95, s[16:17]
  v_mov_b32_dpp v24, v88 quad_perm:[0,0,0,0] row_mask:0xf bank_mask:0xf
  v_add_f32_dpp v24, v89, v24 quad_perm:[1,1,1,1] row_mask:0xf bank_mask:0xf
  v_add_f32_dpp v24, v90, v24 quad_perm:[2,2,2,2] row_mask:0xf bank_mask:0xf
  v_add_f32_dpp v24, v91, v24 quad_perm:[3,3,3,3] row_mask:0xf bank_mask:0xf
  s_waitcnt vmcnt(6)
  v_mfma_f32_16x16x32_bf16 v[68:71], v[228:231], v[44:47], 0
  v_permlane16_swap_b32 v37, v24
  s_nop 1
  v_add_f32_dpp v37, v24, v37 row_half_mirror row_mask:0xf bank_mask:0xf
  v_cvt_pk_bf16_f32 v37, v37, v37
  v_and_b32 v37, 0xffff0000, v37
  v_mul_f32 v37, s26, v37
  v_cvt_pk_bf16_f32 v37, v37, v37
  v_and_b32 v37, 0xffff0000, v37
  v_max_f32 v60, v60, v37
  s_waitcnt vmcnt(5)
  v_mfma_f32_16x16x32_bf16 v[72:75], v[232:235], v[40:43], 0
  s_waitcnt vmcnt(4)
  v_mfma_f32_16x16x32_bf16 v[76:79], v[236:239], v[44:47], 0
  v_cndmask_b32 v64, v64, v68, s[16:17]
  v_cndmask_b32 v65, v65, v69, s[16:17]
  v_cndmask_b32 v66, v66, v70, s[16:17]
  v_cndmask_b32 v67, v67, v71, s[16:17]
  v_mov_b32_dpp v38, v64 quad_perm:[0,0,0,0] row_mask:0xf bank_mask:0xf
  v_add_f32_dpp v38, v65, v38 quad_perm:[1,1,1,1] row_mask:0xf bank_mask:0xf
  v_add_f32_dpp v38, v66, v38 quad_perm:[2,2,2,2] row_mask:0xf bank_mask:0xf
  v_add_f32_dpp v38, v67, v38 quad_perm:[3,3,3,3] row_mask:0xf bank_mask:0xf
  s_waitcnt vmcnt(3)
  v_mfma_f32_16x16x32_bf16 v[80:83], v[240:243], v[40:43], 0
  v_cndmask_b32 v72, v72, v76, s[16:17]
  v_cndmask_b32 v73, v73, v77, s[16:17]
  v_cndmask_b32 v74, v74, v78, s[16:17]
  v_cndmask_b32 v75, v75, v79, s[16:17]
  v_mov_b32_dpp v24, v72 quad_perm:[0,0,0,0] row_mask:0xf bank_mask:0xf
  v_add_f32_dpp v24, v73, v24 quad_perm:[1,1,1,1] row_mask:0xf bank_mask:0xf
  v_add_f32_dpp v24, v74, v24 quad_perm:[2,2,2,2] row_mask:0xf bank_mask:0xf
  v_add_f32_dpp v24, v75, v24 quad_perm:[3,3,3,3] row_mask:0xf bank_mask:0xf
  s_waitcnt vmcnt(2)
  v_mfma_f32_16x16x32_bf16 v[84:87], v[244:247], v[44:47], 0
  v_permlane16_swap_b32 v38, v24
  s_nop 1
  v_add_f32_dpp v38, v24, v38 row_half_mirror row_mask:0xf bank_mask:0xf
  v_cvt_pk_bf16_f32 v38, v38, v38
  v_and_b32 v38, 0xffff0000, v38
  v_mul_f32 v38, s26, v38
  v_cvt_pk_bf16_f32 v38, v38, v38
  v_and_b32 v38, 0xffff0000, v38
  v_max_f32 v60, v60, v38
  s_waitcnt vmcnt(1)
  v_mfma_f32_16x16x32_bf16 v[88:91], v[248:251], v[40:43], 0
  s_waitcnt vmcnt(0)
  v_mfma_f32_16x16x32_bf16 v[92:95], v[252:255], v[44:47], 0
  v_cndmask_b32 v80, v80, v84, s[16:17]
  v_cndmask_b32 v81, v81, v85, s[16:17]
  v_cndmask_b32 v82, v82, v86, s[16:17]
  v_cndmask_b32 v83, v83, v87, s[16:17]
  v_mov_b32_dpp v39, v80 quad_perm:[0,0,0,0] row_mask:0xf bank_mask:0xf
  v_add_f32_dpp v39, v81, v39 quad_perm:[1,1,1,1] row_mask:0xf bank_mask:0xf
  v_add_f32_dpp v39, v82, v39 quad_perm:[2,2,2,2] row_mask:0xf bank_mask:0xf
  v_add_f32_dpp v39, v83, v39 quad_perm:[3,3,3,3] row_mask:0xf bank_mask:0xf
  v_cndmask_b32 v88, v88, v92, s[16:17]
  v_cndmask_b32 v89, v89, v93, s[16:17]
  v_cndmask_b32 v90, v90, v94, s[16:17]
  v_cndmask_b32 v91, v91, v95, s[16:17]
  v_mov_b32_dpp v24, v88 quad_perm:[0,0,0,0] row_mask:0xf bank_mask:0xf
  v_add_f32_dpp v24, v89, v24 quad_perm:[1,1,1,1] row_mask:0xf bank_mask:0xf
  v_add_f32_dpp v24, v90, v24 quad_perm:[2,2,2,2] row_mask:0xf bank_mask:0xf
  v_add_f32_dpp v24, v91, v24 quad_perm:[3,3,3,3] row_mask:0xf bank_mask:0xf
  s_nop 1
  v_permlane16_swap_b32 v39, v24
  s_nop 1
  v_add_f32_dpp v39, v24, v39 row_half_mirror row_mask:0xf bank_mask:0xf
  v_cvt_pk_bf16_f32 v39, v39, v39
  v_and_b32 v39, 0xffff0000, v39
  v_mul_f32 v39, s26, v39
  v_cvt_pk_bf16_f32 v39, v39, v39
  v_and_b32 v39, 0xffff0000, v39
  v_max_f32 v60, v60, v39
  s_nop 1
  v_max_f32_dpp v60, v60, v60 row_ror:8 row_mask:0xf bank_mask:0xf
  s_nop 1
  v_max_f32_dpp v60, v60, v60 row_ror:4 row_mask:0xf bank_mask:0xf
  v_mov_b32 v16, v60
  s_nop 1
  v_permlane16_swap_b32 v60, v16
  v_max_f32 v60, v60, v16
  v_mov_b32 v16, v60
  s_nop 1
  v_permlane32_swap_b32 v60, v16
  v_max_f32 v60, v60, v16
  s_mov_b32 s26, 0x3fb8aa3b
  v_sub_f32 v32, v32, v60
  v_sub_f32 v33, v33, v60
  v_sub_f32 v34, v34, v60
  v_sub_f32 v35, v35, v60
  v_sub_f32 v36, v36, v60
  v_sub_f32 v37, v37, v60
  v_sub_f32 v38, v38, v60
  v_sub_f32 v39, v39, v60
  v_mul_f32 v32, s26, v32
  v_mul_f32 v33, s26, v33
  v_mul_f32 v34, s26, v34
  v_mul_f32 v35, s26, v35
  v_mul_f32 v36, s26, v36
  v_mul_f32 v37, s26, v37
  v_mul_f32 v38, s26, v38
  v_mul_f32 v39, s26, v39
  v_exp_f32 v32, v32
  v_exp_f32 v33, v33
  v_exp_f32 v34, v34
  v_exp_f32 v35, v35
  v_exp_f32 v36, v36
  v_exp_f32 v37, v37
  v_exp_f32 v38, v38
  v_exp_f32 v39, v39
  v_add_f32 v61, v32, v33
  v_add_f32 v61, v61, v34
  v_add_f32 v61, v61, v35
  v_add_f32 v61, v61, v36
  v_add_f32 v61, v61, v37
  v_add_f32 v61, v61, v38
  v_add_f32 v61, v61, v39
  s_nop 1
  v_add_f32_dpp v61, v61, v61 row_ror:8 row_mask:0xf bank_mask:0xf
  s_nop 1
  v_add_f32_dpp v61, v61, v61 row_ror:4 row_mask:0xf bank_mask:0xf
  v_mov_b32 v16, v61
  s_nop 1
  v_permlane16_swap_b32 v61, v16
  v_add_f32 v61, v61, v16
  v_mov_b32 v16, v61
  s_nop 1
  v_permlane32_swap_b32 v61, v16
  v_add_f32 v61, v61, v16
  v_or_b32 v60, s76, v60
  v_bfi_b32 v61, v63, s76, v61
  v_mov_b32 v62, s76
  v_mov_b32 v63, s76
  v_mov_b32 v16, s99
  s_cmp_eq_u32 s2, 0
  s_cselect_b32 s4, 0x100, 0
  s_or_b32 s24, s24, s4
  s_mov_b64 exec, 1
  s_bitcmp1_b32 s24, 8
  s_cbranch_scc1 L_far_s
  buffer_store_dwordx4 v[60:63], v16, s[72:75], 0 offen
L_back_s:
  s_mov_b64 exec, -1
  s_setprio 0
  s_lshl3_add_u32 s4, s8, s10
  s_lshl_b32 s4, s4, 7
  v_lshl_add_u32 v31, v0, 1, s4
  buffer_load_ushort v5, v31, s[40:43], 0 offen
  s_cmp_lg_u32 s79, 0
  s_cbranch_scc0 L_sk_fg
  s_lshl_b32 s4, s14, 11
  s_lshl_b32 s5, s8, 10
  s_add_u32 s4, s4, s5
  s_add_u32 s4, s4, 262144
  v_lshl_add_u32 v13, v0, 4, s4
  buffer_load_dwordx4 v[112:115], v13, s[72:75], 0 offen sc1
L_sk_fg:
  buffer_load_dwordx4 v[128:131], v2, s[48:51], 0 offen offset:0 nt
  s_xor_b32 s4, s98, 1024
  s_add_u32 m0, s4, s96
  s_xor_b32 s4, s97, 4096
  buffer_load_dwordx4 v4, s[56:59], s4 offen  lds
  buffer_load_dwordx4 v[132:135], v2, s[48:51], 0 offen offset:1024 nt
  buffer_load_dwordx4 v[136:139], v2, s[48:51], 0 offen offset:512 nt
  s_xor_b32 s4, s98, 3072
  s_add_u32 m0, s4, s96
  s_xor_b32 s4, s97, 5120
  buffer_load_dwordx4 v4, s[56:59], s4 offen  lds
  buffer_load_dwordx4 v[140:143], v2, s[48:51], 0 offen offset:1536 nt
  s_xor_b32 s4, s98, 4096
  s_add_u32 m0, s4, s96
  s_xor_b32 s4, s97, 32768
  buffer_load_dwordx4 v4, s[56:59], s4 offen  lds
  s_mov_b32 s27, 16384
  buffer_load_dwordx4 v[144:147], v2, s[48:51], s27 offen offset:0 nt
  buffer_load_dwordx4 v[148:151], v2, s[48:51], s27 offen offset:1024 nt
  s_xor_b32 s4, s98, 5120
  s_add_u32 m0, s4, s96
  s_xor_b32 s4, s97, 36864
  buffer_load_dwordx4 v4, s[56:59], s4 offen  lds
  buffer_load_dwordx4 v[152:155], v2, s[48:51], s27 offen offset:512 nt
  s_xor_b32 s4, s98, 6144
  s_add_u32 m0, s4, s96
  s_xor_b32 s4, s97, 33792
  buffer_load_dwordx4 v4, s[56:59], s4 offen  lds
  buffer_load_dwordx4 v[156:159], v2, s[48:51], s27 offen offset:1536 nt
  s_mov_b32 s27, 32768
  buffer_load_dwordx4 v[160:163], v2, s[48:51], s27 offen offset:0 nt
  s_xor_b32 s4, s98, 7168
  s_add_u32 m0, s4, s96
  s_xor_b32 s4, s97, 37888
  buffer_load_dwordx4 v4, s[56:59], s4 offen  lds
  buffer_load_dwordx4 v[164:167], v2, s[48:51], s27 offen offset:1024 nt
  s_xor_b32 s4, s98, 8192
  s_add_u32 m0, s4, s96
  s_xor_b32 s4, s97, 65536
  buffer_load_dwordx4 v4, s[56:59], s4 offen  lds
  buffer_load_dwordx4 v[168:171], v2, s[48:51], s27 offen offset:512 nt
  buffer_load_dwordx4 v[172:175], v2, s[48:51], s27 offen offset:1536 nt
  s_xor_b32 s4, s98, 9216
  s_add_u32 m0, s4, s96
  s_xor_b32 s4, s97, 69632
  buffer_load_dwordx4 v4, s[56:59], s4 offen  lds
  s_mov_b32 s27, 49152
  buffer_load_dwordx4 v[176:179], v2, s[48:51], s27 offen offset:0 nt
  s_cmp_lg_u32 s79, 0
  s_cbranch_scc0 L_sk_fh
  s_waitcnt vmcnt(21)
  v_xor_b32 v112, s25, v112
  v_xor_b32 v113, s25, v113
  v_xor_b32 v114, s25, v114
  v_xor_b32 v115, s25, v115
  v_or3_b32 v20, v112, v113, v114
  v_or_b32 v20, v20, v115
  v_and_b32 v20, 63, v20
  v_cmp_ne_u32 vcc, 0, v20
  s_nop 4
  s_cbranch_vccz L_fg_ok
  s_mov_b32 s101, 0
L_fg_poll:
  s_sleep 8
  s_cmp_lt_u32 s101, 4
  s_cbranch_scc1 L_fg_ld
  buffer_inv sc1
  s_waitcnt vmcnt(0)
L_fg_ld:
  buffer_load_dwordx4 v[112:115], v13, s[72:75], 0 offen sc1
  s_waitcnt vmcnt(0)
  v_xor_b32 v112, s25, v112
  v_xor_b32 v113, s25, v113
  v_xor_b32 v114, s25, v114
  v_xor_b32 v115, s25, v115
  v_or3_b32 v20, v112, v113, v114
  v_or_b32 v20, v20, v115
  v_and_b32 v20, 63, v20
  v_cmp_ne_u32 vcc, 0, v20
  s_add_u32 s101, s101, 1
  s_cmp_ge_u32 s101, 0x4000
  s_cbranch_scc1 L_fg_ok
  s_nop 4
  s_cbranch_vccnz L_fg_poll
L_fg_ok:
  s_nop 1
  v_permlane32_swap_b32 v112, v113
  v_permlane32_swap_b32 v114, v115
  v_add_f32 v112, v112, v113
  v_add_f32 v114, v114, v115
  s_nop 1
  v_permlane16_swap_b32 v112, v114
  v_add_f32 v112, v112, v114
  s_nop 1
  v_add_f32_dpp v112, v112, v112 row_ror:8 row_mask:0xf bank_mask:0xf
  v_cvt_pk_bf16_f32 v20, v112, v112
  v_and_b32 v20, 0xffff0000, v20
  s_nop 1
  v_mov_b32_dpp v21, v20 row_shl:4 row_mask:0xf bank_mask:0xf
  v_mul_f32 v23, v20, v20
  v_mul_f32 v23, 0x3d372713, v23
  v_fma_f32 v23, v23, v20, v20
  v_mul_f32 v23, 0xc0135761, v23
  v_exp_f32 v23, v23
  s_nop 0
  v_add_f32 v23, 1.0, v23
  v_rcp_f32 v23, v23
  s_nop 0
  v_mul_f32 v23, v20, v23
  v_cvt_pk_bf16_f32 v23, v23, v23
  v_and_b32 v23, 0xffff0000, v23
  v_mul_f32 v23, v23, v21
  v_cvt_pk_bf16_f32 v23, v23, v23
  v_mov_b32 v20, 0
  v_mov_b32 v21, 1
  s_mov_b32 exec_lo, 0x000f000f
  s_mov_b32 exec_hi, 0x000f000f
  ds_write_b16 v120, v23 offset:8224
  s_waitcnt lgkmcnt(0)
  s_mov_b64 exec, 1
  ds_add_u32 v20, v21 offset:8196
  s_mov_b64 exec, -1
L_sk_fh:
  s_xor_b32 s4, s98, 10240
  s_add_u32 m0, s4, s96
  s_xor_b32 s4, s97, 66560
  buffer_load_dwordx4 v4, s[56:59], s4 offen  lds
  buffer_load_dwordx4 v[180:183], v2, s[48:51], s27 offen offset:1024 nt
  buffer_load_dwordx4 v[184:187], v2, s[48:51], s27 offen offset:512 nt
  s_xor_b32 s4, s98, 11264
  s_add_u32 m0, s4, s96
  s_xor_b32 s4, s97, 70656
  buffer_load_dwordx4 v4, s[56:59], s4 offen  lds
  buffer_load_dwordx4 v[188:191], v2, s[48:51], s27 offen offset:1536 nt
  s_xor_b32 s4, s98, 12288
  s_add_u32 m0, s4, s96
  s_xor_b32 s4, s97, 98304
  buffer_load_dwordx4 v4, s[56:59], s4 offen  lds
  s_mov_b32 s27, 65536
  buffer_load_dwordx4 v[192:195], v2, s[48:51], s27 offen offset:0 nt
  v_cvt_pk_bf16_f32 v32, v32, v32
  v_cvt_pk_bf16_f32 v33, v33, v33
  v_cvt_pk_bf16_f32 v34, v34, v34
  v_cvt_pk_bf16_f32 v35, v35, v35
  v_cvt_pk_bf16_f32 v36, v36, v36
  v_cvt_pk_bf16_f32 v37, v37, v37
  v_cvt_pk_bf16_f32 v38, v38, v38
  v_cvt_pk_bf16_f32 v39, v39, v39
  v_and_b32_dpp v16, v32, v8 row_newbcast:0 row_mask:0xf bank_mask:0xf
  v_and_b32_dpp v17, v32, v9 row_newbcast:0 row_mask:0xf bank_mask:0xf
  v_and_b32_dpp v18, v32, v10 row_newbcast:0 row_mask:0xf bank_mask:0xf
  v_and_b32_dpp v19, v32, v11 row_newbcast:0 row_mask:0xf bank_mask:0xf
  v_and_b32_dpp v20, v32, v8 row_newbcast:4 row_mask:0xf bank_mask:0xf
  v_and_b32_dpp v21, v32, v9 row_newbcast:4 row_mask:0xf bank_mask:0xf
  v_and_b32_dpp v22, v32, v10 row_newbcast:4 row_mask:0xf bank_mask:0xf
  v_and_b32_dpp v23, v32, v11 row_newbcast:4 row_mask:0xf bank_mask:0xf
  s_waitcnt vmcnt(27)
  v_mfma_f32_16x16x32_bf16 v[24:27], v[128:131], v[16:19], 0
  buffer_load_dwordx4 v[196:199], v2, s[48:51], s27 offen offset:1024 nt
  s_xor_b32 s4, s98, 13312
  s_add_u32 m0, s4, s96
  s_xor_b32 s4, s97, 102400
  buffer_load_dwordx4 v4, s[56:59], s4 offen  lds
  v_and_b32_dpp v16, v32, v8 row_newbcast:8 row_mask:0xf bank_mask:0xf
  v_and_b32_dpp v17, v32, v9 row_newbcast:8 row_mask:0xf bank_mask:0xf
  v_and_b32_dpp v18, v32, v10 row_newbcast:8 row_mask:0xf bank_mask:0xf
  v_and_b32_dpp v19, v32, v11 row_newbcast:8 row_mask:0xf bank_mask:0xf
  s_waitcnt vmcnt(27)
  v_mfma_f32_16x16x32_bf16 v[24:27], v[132:135], v[20:23], v[24:27]
  buffer_load_dwordx4 v[200:203], v2, s[48:51], s27 offen offset:512 nt
  s_xor_b32 s4, s98, 14336
  s_add_u32 m0, s4, s96
  s_xor_b32 s4, s97, 99328
  buffer_load_dwordx4 v4, s[56:59], s4 offen  lds
  v_and_b32_dpp v20, v32, v8 row_newbcast:12 row_mask:0xf bank_mask:0xf
  v_and_b32_dpp v21, v32, v9 row_newbcast:12 row_mask:0xf bank_mask:0xf
  v_and_b32_dpp v22, v32, v10 row_newbcast:12 row_mask:0xf bank_mask:0xf
  v_and_b32_dpp v23, v32, v11 row_newbcast:12 row_mask:0xf bank_mask:0xf
  s_waitcnt vmcnt(28)
  v_mfma_f32_16x16x32_bf16 v[24:27], v[136:139], v[16:19], v[24:27]
  buffer_load_dwordx4 v[204:207], v2, s[48:51], s27 offen offset:1536 nt
  v_and_b32_dpp v16, v33, v8 row_newbcast:0 row_mask:0xf bank_mask:0xf
  v_and_b32_dpp v17, v33, v9 row_newbcast:0 row_mask:0xf bank_mask:0xf
  v_and_b32_dpp v18, v33, v10 row_newbcast:0 row_mask:0xf bank_mask:0xf
  v_and_b32_dpp v19, v33, v11 row_newbcast:0 row_mask:0xf bank_mask:0xf
  s_waitcnt vmcnt(27)
  v_mfma_f32_16x16x32_bf16 v[24:27], v[140:143], v[20:23], v[24:27]
  s_mov_b32 s27, 81920
  buffer_load_dwordx4 v[208:211], v2, s[48:51], s27 offen offset:0 nt
  s_xor_b32 s4, s98, 15360
  s_add_u32 m0, s4, s96
  s_xor_b32 s4, s97, 103424
  buffer_load_dwordx4 v4, s[56:59], s4 offen  lds
  v_and_b32_dpp v20, v33, v8 row_newbcast:4 row_mask:0xf bank_mask:0xf
  v_and_b32_dpp v21, v33, v9 row_newbcast:4 row_mask:0xf bank_mask:0xf
  v_and_b32_dpp v22, v33, v10 row_newbcast:4 row_mask:0xf bank_mask:0xf
  v_and_b32_dpp v23, v33, v11 row_newbcast:4 row_mask:0xf bank_mask:0xf
  s_waitcnt vmcnt(27)
  v_mfma_f32_16x16x32_bf16 v[24:27], v[144:147], v[16:19], v[24:27]
  buffer_load_dwordx4 v[212:215], v2, s[48:51], s27 offen offset:1024 nt
  v_and_b32_dpp v16, v33, v8 row_newbcast:8 row_mask:0xf bank_mask:0xf
  v_and_b32_dpp v17, v33, v9 row_newbcast:8 row_mask:0xf bank_mask:0xf
  v_and_b32_dpp v18, v33, v10 row_newbcast:8 row_mask:0xf bank_mask:0xf
  v_and_b32_dpp v19, v33, v11 row_newbcast:8 row_mask:0xf bank_mask:0xf
  s_waitcnt vmcnt(27)
  v_mfma_f32_16x16x32_bf16 v[24:27], v[148:151], v[20:23], v[24:27]
  buffer_load_dwordx4 v[216:219], v2, s[48:51], s27 offen offset:512 nt
  v_and_b32_dpp v20, v33, v8 row_newbcast:12 row_mask:0xf bank_mask:0xf
  v_and_b32_dpp v21, v33, v9 row_newbcast:12 row_mask:0xf bank_mask:0xf
  v_and_b32_dpp v22, v33, v10 row_newbcast:12 row_mask:0xf bank_mask:0xf
  v_and_b32_dpp v23, v33, v11 row_newbcast:12 row_mask:0xf bank_mask:0xf
  s_waitcnt vmcnt(26)
  v_mfma_f32_16x16x32_bf16 v[24:27], v[152:155], v[16:19], v[24:27]
  buffer_load_dwordx4 v[220:223], v2, s[48:51], s27 offen offset:1536 nt
  v_and_b32_dpp v16, v34, v8 row_newbcast:0 row_mask:0xf bank_mask:0xf
  v_and_b32_dpp v17, v34, v9 row_newbcast:0 row_mask:0xf bank_mask:0xf
  v_and_b32_dpp v18, v34, v10 row_newbcast:0 row_mask:0xf bank_mask:0xf
  v_and_b32_dpp v19, v34, v11 row_newbcast:0 row_mask:0xf bank_mask:0xf
  s_waitcnt vmcnt(25)
  v_mfma_f32_16x16x32_bf16 v[24:27], v[156:159], v[20:23], v[24:27]
  s_mov_b32 s27, 98304
  buffer_load_dwordx4 v[224:227], v2, s[48:51], s27 offen offset:0 nt
  v_and_b32_dpp v20, v34, v8 row_newbcast:4 row_mask:0xf bank_mask:0xf
  v_and_b32_dpp v21, v34, v9 row_newbcast:4 row_mask:0xf bank_mask:0xf
  v_and_b32_dpp v22, v34, v10 row_newbcast:4 row_mask:0xf bank_mask:0xf
  v_and_b32_dpp v23, v34, v11 row_newbcast:4 row_mask:0xf bank_mask:0xf
  s_waitcnt vmcnt(25)
  v_mfma_f32_16x16x32_bf16 v[24:27], v[160:163], v[16:19], v[24:27]
  buffer_load_dwordx4 v[228:231], v2, s[48:51], s27 offen offset:1024 nt
  v_and_b32_dpp v16, v34, v8 row_newbcast:8 row_mask:0xf bank_mask:0xf
  v_and_b32_dpp v17, v34, v9 row_newbcast:8 row_mask:0xf bank_mask:0xf
  v_and_b32_dpp v18, v34, v10 row_newbcast:8 row_mask:0xf bank_mask:0xf
  v_and_b32_dpp v19, v34, v11 row_newbcast:8 row_mask:0xf bank_mask:0xf
  s_waitcnt vmcnt(24)
  v_mfma_f32_16x16x32_bf16 v[24:27], v[164:167], v[20:23], v[24:27]
  buffer_load_dwordx4 v[232:235], v2, s[48:51], s27 offen offset:512 nt
  v_and_b32_dpp v20, v34, v8 row_newbcast:12 row_mask:0xf bank_mask:0xf
  v_and_b32_dpp v21, v34, v9 row_newbcast:12 row_mask:0xf bank_mask:0xf
  v_and_b32_dpp v22, v34, v10 row_newbcast:12 row_mask:0xf bank_mask:0xf
  v_and_b32_dpp v23, v34, v11 row_newbcast:12 row_mask:0xf bank_mask:0xf
  s_waitcnt vmcnt(23)
  v_mfma_f32_16x16x32_bf16 v[24:27], v[168:171], v[16:19], v[24:27]
  buffer_load_dwordx4 v[236:239], v2, s[48:51], s27 offen offset:1536 nt
  v_and_b32_dpp v16, v35, v8 row_newbcast:0 row_mask:0xf bank_mask:0xf
  v_and_b32_dpp v17, v35, v9 row_newbcast:0 row_mask:0xf bank_mask:0xf
  v_and_b32_dpp v18, v35, v10 row_newbcast:0 row_mask:0xf bank_mask:0xf
  v_and_b32_dpp v19, v35, v11 row_newbcast:0 row_mask:0xf bank_mask:0xf
  s_waitcnt vmcnt(23)
  v_mfma_f32_16x16x32_bf16 v[24:27], v[172:175], v[20:23], v[24:27]
  s_mov_b32 s27, 114688
  buffer_load_dwordx4 v[240:243], v2, s[48:51], s27 offen offset:0 nt
  v_and_b32_dpp v20, v35, v8 row_newbcast:4 row_mask:0xf bank_mask:0xf
  v_and_b32_dpp v21, v35, v9 row_newbcast:4 row_mask:0xf bank_mask:0xf
  v_and_b32_dpp v22, v35, v10 row_newbcast:4 row_mask:0xf bank_mask:0xf
  v_and_b32_dpp v23, v35, v11 row_newbcast:4 row_mask:0xf bank_mask:0xf
  s_waitcnt vmcnt(22)
  v_mfma_f32_16x16x32_bf16 v[24:27], v[176:179], v[16:19], v[24:27]
  buffer_load_dwordx4 v[244:247], v2, s[48:51], s27 offen offset:1024 nt
  v_and_b32_dpp v16, v35, v8 row_newbcast:8 row_mask:0xf bank_mask:0xf
  v_and_b32_dpp v17, v35, v9 row_newbcast:8 row_mask:0xf bank_mask:0xf
  v_and_b32_dpp v18, v35, v10 row_newbcast:8 row_mask:0xf bank_mask:0xf
  v_and_b32_dpp v19, v35, v11 row_newbcast:8 row_mask:0xf bank_mask:0xf
  s_waitcnt vmcnt(21)
  v_mfma_f32_16x16x32_bf16 v[24:27], v[180:183], v[20:23], v[24:27]
  buffer_load_dwordx4 v[248:251], v2, s[48:51], s27 offen offset:512 nt
  v_and_b32_dpp v20, v35, v8 row_newbcast:12 row_mask:0xf bank_mask:0xf
  v_and_b32_dpp v21, v35, v9 row_newbcast:12 row_mask:0xf bank_mask:0xf
  v_and_b32_dpp v22, v35, v10 row_newbcast:12 row_mask:0xf bank_mask:0xf
  v_and_b32_dpp v23, v35, v11 row_newbcast:12 row_mask:0xf bank_mask:0xf
  s_waitcnt vmcnt(21)
  v_mfma_f32_16x16x32_bf16 v[24:27], v[184:187], v[16:19], v[24:27]
  buffer_load_dwordx4 v[252:255], v2, s[48:51], s27 offen offset:1536 nt
  v_and_b32_dpp v16, v36, v8 row_newbcast:0 row_mask:0xf bank_mask:0xf
  v_and_b32_dpp v17, v36, v9 row_newbcast:0 row_mask:0xf bank_mask:0xf
  v_and_b32_dpp v18, v36, v10 row_newbcast:0 row_mask:0xf bank_mask:0xf
  v_and_b32_dpp v19, v36, v11 row_newbcast:0 row_mask:0xf bank_mask:0xf
  s_waitcnt vmcnt(20)
  v_mfma_f32_16x16x32_bf16 v[24:27], v[188:191], v[20:23], v[24:27]
  v_lshlrev_b32 v15, 1, v15
  v_lshlrev_b32 v1, 3, v15
  s_lshl_b32 s100, s11, 9
  s_add_u32 s100, s100, 65536
  v_add_u32 v1, s100, v1
  v_and_b32 v2, 7, v0
  v_lshlrev_b32 v2, 4, v2
  s_mov_b32 exec_lo, 0
  v_add_u32 v1, 65536, v2
  s_mov_b32 exec_lo, -1
  s_cmp_eq_u32 s10, 0
  s_cbranch_scc0 L_sk_hl
  buffer_load_dwordx4 v[56:59], v1, s[72:75], 0 offen sc1
L_sk_hl:
  v_and_b32 v4, 1, v12
  v_lshlrev_b32 v4, 4, v4
  v_and_b32_dpp v20, v36, v8 row_newbcast:4 row_mask:0xf bank_mask:0xf
  v_and_b32_dpp v21, v36, v9 row_newbcast:4 row_mask:0xf bank_mask:0xf
  v_and_b32_dpp v22, v36, v10 row_newbcast:4 row_mask:0xf bank_mask:0xf
  v_and_b32_dpp v23, v36, v11 row_newbcast:4 row_mask:0xf bank_mask:0xf
  s_waitcnt vmcnt(18)
  v_mfma_f32_16x16x32_bf16 v[24:27], v[192:195], v[16:19], v[24:27]
  v_lshlrev_b32 v5, 16, v5
  s_mov_b32 s13, 0x38800000
  v_cmp_le_f32 vcc, s13, |v5|
  s_mov_b32 s13, 0x42000000
  v_mov_b32 v63, 0xffff
  s_cmp_lg_u64 vcc, 0
  s_cselect_b32 s12, 0, 0x39800000
  v_and_b32_dpp v16, v36, v8 row_newbcast:8 row_mask:0xf bank_mask:0xf
  v_and_b32_dpp v17, v36, v9 row_newbcast:8 row_mask:0xf bank_mask:0xf
  v_and_b32_dpp v18, v36, v10 row_newbcast:8 row_mask:0xf bank_mask:0xf
  v_and_b32_dpp v19, v36, v11 row_newbcast:8 row_mask:0xf bank_mask:0xf
  s_waitcnt vmcnt(17)
  v_mfma_f32_16x16x32_bf16 v[24:27], v[196:199], v[20:23], v[24:27]
  v_and_b32_dpp v20, v36, v8 row_newbcast:12 row_mask:0xf bank_mask:0xf
  v_and_b32_dpp v21, v36, v9 row_newbcast:12 row_mask:0xf bank_mask:0xf
  v_and_b32_dpp v22, v36, v10 row_newbcast:12 row_mask:0xf bank_mask:0xf
  v_and_b32_dpp v23, v36, v11 row_newbcast:12 row_mask:0xf bank_mask:0xf
  s_waitcnt vmcnt(15)
  v_mfma_f32_16x16x32_bf16 v[24:27], v[200:203], v[16:19], v[24:27]
  v_and_b32_dpp v16, v37, v8 row_newbcast:0 row_mask:0xf bank_mask:0xf
  v_and_b32_dpp v17, v37, v9 row_newbcast:0 row_mask:0xf bank_mask:0xf
  v_and_b32_dpp v18, v37, v10 row_newbcast:0 row_mask:0xf bank_mask:0xf
  v_and_b32_dpp v19, v37, v11 row_newbcast:0 row_mask:0xf bank_mask:0xf
  s_waitcnt vmcnt(13)
  v_mfma_f32_16x16x32_bf16 v[24:27], v[204:207], v[20:23], v[24:27]
  v_and_b32_dpp v20, v37, v8 row_newbcast:4 row_mask:0xf bank_mask:0xf
  v_and_b32_dpp v21, v37, v9 row_newbcast:4 row_mask:0xf bank_mask:0xf
  v_and_b32_dpp v22, v37, v10 row_newbcast:4 row_mask:0xf bank_mask:0xf
  v_and_b32_dpp v23, v37, v11 row_newbcast:4 row_mask:0xf bank_mask:0xf
  s_waitcnt vmcnt(12)
  v_mfma_f32_16x16x32_bf16 v[24:27], v[208:211], v[16:19], v[24:27]
  v_and_b32_dpp v16, v37, v8 row_newbcast:8 row_mask:0xf bank_mask:0xf
  v_and_b32_dpp v17, v37, v9 row_newbcast:8 row_mask:0xf bank_mask:0xf
  v_and_b32_dpp v18, v37, v10 row_newbcast:8 row_mask:0xf bank_mask:0xf
  v_and_b32_dpp v19, v37, v11 row_newbcast:8 row_mask:0xf bank_mask:0xf
  s_waitcnt vmcnt(10)
  v_mfma_f32_16x16x32_bf16 v[24:27], v[212:215], v[20:23], v[24:27]
  v_and_b32_dpp v20, v37, v8 row_newbcast:12 row_mask:0xf bank_mask:0xf
  v_and_b32_dpp v21, v37, v9 row_newbcast:12 row_mask:0xf bank_mask:0xf
  v_and_b32_dpp v22, v37, v10 row_newbcast:12 row_mask:0xf bank_mask:0xf
  v_and_b32_dpp v23, v37, v11 row_newbcast:12 row_mask:0xf bank_mask:0xf
  s_waitcnt vmcnt(9)
  v_mfma_f32_16x16x32_bf16 v[24:27], v[216:219], v[16:19], v[24:27]
  v_and_b32_dpp v16, v38, v8 row_newbcast:0 row_mask:0xf bank_mask:0xf
  v_and_b32_dpp v17, v38, v9 row_newbcast:0 row_mask:0xf bank_mask:0xf
  v_and_b32_dpp v18, v38, v10 row_newbcast:0 row_mask:0xf bank_mask:0xf
  v_and_b32_dpp v19, v38, v11 row_newbcast:0 row_mask:0xf bank_mask:0xf
  s_waitcnt vmcnt(8)
  v_mfma_f32_16x16x32_bf16 v[24:27], v[220:223], v[20:23], v[24:27]
  v_and_b32_dpp v20, v38, v8 row_newbcast:4 row_mask:0xf bank_mask:0xf
  v_and_b32_dpp v21, v38, v9 row_newbcast:4 row_mask:0xf bank_mask:0xf
  v_and_b32_dpp v22, v38, v10 row_newbcast:4 row_mask:0xf bank_mask:0xf
  v_and_b32_dpp v23, v38, v11 row_newbcast:4 row_mask:0xf bank_mask:0xf
  s_waitcnt vmcnt(7)
  v_mfma_f32_16x16x32_bf16 v[24:27], v[224:227], v[16:19], v[24:27]
  v_xor_b32 v28, 32, v3
  v_xor_b32 v29, 64, v3
  v_xor_b32 v30, 96, v3
  v_mov_b32 v40, 0
  v_mov_b32 v44, 0
  v_mov_b32 v48, 0
  v_mov_b32 v52, 0
  s_cmp_lg_u32 s15, 0
  s_cbranch_scc0 L_sk_wd
  v_mov_b32 v128, 0
  s_mov_b32 s101, 0
L_hw:
  ds_read_b32 v129, v128 offset:8196
  s_add_u32 s101, s101, 1
  s_cmp_ge_u32 s101, 0x40000
  s_cbranch_scc1 L_hw_ok
  s_waitcnt lgkmcnt(0)
  v_readfirstlane_b32 s4, v129
  s_nop 0
  s_cmp_lt_u32 s4, 1
  s_cbranch_scc0 L_hw_ok
  s_sleep 1
  s_branch L_hw
L_hw_ok:
  v_lshlrev_b32 v128, 3, v12
  ds_read_b64 v[136:137], v128 offset:8224
  ds_read_b64_tr_b16 v[128:129], v3 offset:16384
  ds_read_b64_tr_b16 v[130:131], v28 offset:16384
  ds_read_b64_tr_b16 v[132:133], v29 offset:16384
  ds_read_b64_tr_b16 v[134:135], v30 offset:16384
  s_mov_b32 vcc_lo, 0x00010001
  s_mov_b32 vcc_hi, 0x00010001
  s_waitcnt lgkmcnt(0)
  v_cndmask_b32 v136, 0, v136, vcc
  v_cndmask_b32 v137, 0, v137, vcc
  s_nop 1
  v_mfma_f32_16x16x16_bf16 v[40:43], v[136:137], v[128:129], 0
  v_mfma_f32_16x16x16_bf16 v[44:47], v[136:137], v[130:131], 0
  v_mfma_f32_16x16x16_bf16 v[48:51], v[136:137], v[132:133], 0
  v_mfma_f32_16x16x16_bf16 v[52:55], v[136:137], v[134:135], 0
L_sk_wd:
  ds_read_b64_tr_b16 v[64:65], v3 offset:0
  ds_read_b64_tr_b16 v[66:67], v3 offset:2048
  ds_read_b64_tr_b16 v[68:69], v3 offset:4096
  ds_read_b64_tr_b16 v[70:71], v3 offset:6144
  ds_read_b64_tr_b16 v[72:73], v3 offset:8192
  ds_read_b64_tr_b16 v[74:75], v3 offset:10240
  ds_read_b64_tr_b16 v[76:77], v3 offset:12288
  ds_read_b64_tr_b16 v[78:79], v3 offset:14336
  ds_read_b64_tr_b16 v[80:81], v28 offset:0
  ds_read_b64_tr_b16 v[82:83], v28 offset:2048
  ds_read_b64_tr_b16 v[84:85], v28 offset:4096
  ds_read_b64_tr_b16 v[86:87], v28 offset:6144
  ds_read_b64_tr_b16 v[88:89], v28 offset:8192
  ds_read_b64_tr_b16 v[90:91], v28 offset:10240
  ds_read_b64_tr_b16 v[92:93], v28 offset:12288
  ds_read_b64_tr_b16 v[94:95], v28 offset:14336
  ds_read_b64_tr_b16 v[96:97], v29 offset:0
  ds_read_b64_tr_b16 v[98:99], v29 offset:2048
  ds_read_b64_tr_b16 v[100:101], v29 offset:4096
  ds_read_b64_tr_b16 v[102:103], v29 offset:6144
  ds_read_b64_tr_b16 v[104:105], v29 offset:8192
  ds_read_b64_tr_b16 v[106:107], v29 offset:10240
  ds_read_b64_tr_b16 v[108:109], v29 offset:12288
  ds_read_b64_tr_b16 v[110:111], v29 offset:14336
  ds_read_b64_tr_b16 v[112:113], v30 offset:0
  ds_read_b64_tr_b16 v[114:115], v30 offset:2048
  ds_read_b64_tr_b16 v[116:117], v30 offset:4096
  ds_read_b64_tr_b16 v[118:119], v30 offset:6144
  ds_read_b64_tr_b16 v[120:121], v30 offset:8192
  ds_read_b64_tr_b16 v[122:123], v30 offset:10240
  ds_read_b64_tr_b16 v[124:125], v30 offset:12288
  ds_read_b64_tr_b16 v[126:127], v30 offset:14336
  v_mov_b32 v128, 0
  v_mov_b32 v129, 0
  v_mov_b32 v130, 0
  v_mov_b32 v131, 0
  v_mov_b32 v132, 0
  v_mov_b32 v133, 0
  v_mov_b32 v134, 0
  v_mov_b32 v135, 0
  v_mov_b32 v136, 0
  v_mov_b32 v137, 0
  v_mov_b32 v138, 0
  v_mov_b32 v139, 0
  v_mov_b32 v140, 0
  v_mov_b32 v141, 0
  v_mov_b32 v142, 0
  v_mov_b32 v143, 0
  v_bfe_i32 v2, v0, 3, 1
  v_and_b32 v2, 0xaaaaaaaa, v2
  v_or_b32 v2, 0x44444444, v2
  v_and_b32_dpp v16, v38, v8 row_newbcast:8 row_mask:0xf bank_mask:0xf
  v_and_b32_dpp v17, v38, v9 row_newbcast:8 row_mask:0xf bank_mask:0xf
  v_and_b32_dpp v18, v38, v10 row_newbcast:8 row_mask:0xf bank_mask:0xf
  v_and_b32_dpp v19, v38, v11 row_newbcast:8 row_mask:0xf bank_mask:0xf
  s_waitcnt vmcnt(6)
  v_mfma_f32_16x16x32_bf16 v[24:27], v[228:231], v[20:23], v[24:27]
  v_and_b32_dpp v20, v38, v8 row_newbcast:12 row_mask:0xf bank_mask:0xf
  v_and_b32_dpp v21, v38, v9 row_newbcast:12 row_mask:0xf bank_mask:0xf
  v_and_b32_dpp v22, v38, v10 row_newbcast:12 row_mask:0xf bank_mask:0xf
  v_and_b32_dpp v23, v38, v11 row_newbcast:12 row_mask:0xf bank_mask:0xf
  s_waitcnt vmcnt(5)
  v_mfma_f32_16x16x32_bf16 v[24:27], v[232:235], v[16:19], v[24:27]
  v_and_b32_dpp v16, v39, v8 row_newbcast:0 row_mask:0xf bank_mask:0xf
  v_and_b32_dpp v17, v39, v9 row_newbcast:0 row_mask:0xf bank_mask:0xf
  v_and_b32_dpp v18, v39, v10 row_newbcast:0 row_mask:0xf bank_mask:0xf
  v_and_b32_dpp v19, v39, v11 row_newbcast:0 row_mask:0xf bank_mask:0xf
  s_waitcnt vmcnt(4)
  v_mfma_f32_16x16x32_bf16 v[24:27], v[236:239], v[20:23], v[24:27]
  v_and_b32_dpp v20, v39, v8 row_newbcast:4 row_mask:0xf bank_mask:0xf
  v_and_b32_dpp v21, v39, v9 row_newbcast:4 row_mask:0xf bank_mask:0xf
  v_and_b32_dpp v22, v39, v10 row_newbcast:4 row_mask:0xf bank_mask:0xf
  v_and_b32_dpp v23, v39, v11 row_newbcast:4 row_mask:0xf bank_mask:0xf
  s_waitcnt vmcnt(3)
  v_mfma_f32_16x16x32_bf16 v[24:27], v[240:243], v[16:19], v[24:27]
  v_and_b32_dpp v16, v39, v8 row_newbcast:8 row_mask:0xf bank_mask:0xf
  v_and_b32_dpp v17, v39, v9 row_newbcast:8 row_mask:0xf bank_mask:0xf
  v_and_b32_dpp v18, v39, v10 row_newbcast:8 row_mask:0xf bank_mask:0xf
  v_and_b32_dpp v19, v39, v11 row_newbcast:8 row_mask:0xf bank_mask:0xf
  s_waitcnt vmcnt(2)
  v_mfma_f32_16x16x32_bf16 v[24:27], v[244:247], v[20:23], v[24:27]
  v_and_b32_dpp v20, v39, v8 row_newbcast:12 row_mask:0xf bank_mask:0xf
  v_and_b32_dpp v21, v39, v9 row_newbcast:12 row_mask:0xf bank_mask:0xf
  v_and_b32_dpp v22, v39, v10 row_newbcast:12 row_mask:0xf bank_mask:0xf
  v_and_b32_dpp v23, v39, v11 row_newbcast:12 row_mask:0xf bank_mask:0xf
  s_waitcnt vmcnt(1)
  v_mfma_f32_16x16x32_bf16 v[24:27], v[248:251], v[16:19], v[24:27]
  s_waitcnt vmcnt(0)
  v_mfma_f32_16x16x32_bf16 v[24:27], v[252:255], v[20:23], v[24:27]
  s_nop 7
  v_cvt_pk_bf16_f32 v24, v24, v25
  v_cvt_pk_bf16_f32 v25, v26, v27
  ds_write2st64_b32 v6, v24, v25 offset1:4
  s_cmp_eq_u32 s10, 0
  s_cbranch_scc0 L_sk_fin
  s_waitcnt vmcnt(0)
  v_bitop3_b32 v28, v56, v57, s76 bitop3:0x7e
  v_bitop3_b32 v29, v58, v59, s76 bitop3:0x7e
  v_or_b32 v28, v28, v29
  v_and_b32 v28, 255, v28
  v_cmp_ne_u32 vcc, 0, v28
  s_nop 4
  s_cbranch_vccz L_st_ok
  s_mov_b32 s101, 0
L_st_poll:
  s_sleep 32
  buffer_load_dwordx4 v[56:59], v1, s[72:75], 0 offen sc1
  s_waitcnt vmcnt(0)
  v_bitop3_b32 v28, v56, v57, s76 bitop3:0x7e
  v_bitop3_b32 v29, v58, v59, s76 bitop3:0x7e
  v_or_b32 v28, v28, v29
  v_and_b32 v28, 255, v28
  v_cmp_ne_u32 vcc, 0, v28
  s_add_u32 s101, s101, 1
  s_cmp_ge_u32 s101, 0x4000
  s_cbranch_scc1 L_st_ok
  s_nop 4
  s_cbranch_vccnz L_st_poll
L_st_ok:
  s_nop 1
  v_and_b32 v56, 0xffff0000, v56
  v_and_b32 v57, 0xffffff00, v57
  v_mov_b32 v58, v56
  s_nop 1
  v_max_f32_dpp v58, v58, v58 row_ror:8 row_mask:0xf bank_mask:0xf
  s_nop 1
  v_max_f32_dpp v58, v58, v58 row_ror:4 row_mask:0xf bank_mask:0xf
  s_nop 1
  v_max_f32_dpp v58, v58, v58 row_ror:2 row_mask:0xf bank_mask:0xf
  s_nop 1
  v_max_f32_dpp v58, v58, v58 row_ror:1 row_mask:0xf bank_mask:0xf
  v_mov_b32 v59, v58
  s_nop 1
  v_permlane16_swap_b32 v58, v59
  v_max_f32 v58, v58, v59
  v_sub_f32 v56, v56, v58
  v_mul_f32 v56, s26, v56
  v_exp_f32 v56, v56
  s_nop 0
  v_mul_f32 v59, v56, v57
  s_nop 1
  v_add_f32_dpp v59, v59, v59 row_ror:8 row_mask:0xf bank_mask:0xf
  s_nop 1
  v_add_f32_dpp v59, v59, v59 row_ror:4 row_mask:0xf bank_mask:0xf
  s_nop 1
  v_add_f32_dpp v59, v59, v59 row_ror:2 row_mask:0xf bank_mask:0xf
  s_nop 1
  v_add_f32_dpp v59, v59, v59 row_ror:1 row_mask:0xf bank_mask:0xf
  v_mov_b32 v57, v59
  s_nop 1
  v_permlane16_swap_b32 v59, v57
  v_add_f32 v59, v59, v57
  v_rcp_f32 v57, v59
  s_nop 0
  v_mul_f32 v61, v56, v57
  v_fma_f32 v58, -v61, v59, v56
  v_fmac_f32 v61, v58, v57
  v_and_b32 v58, 7, v0
  v_lshlrev_b32 v58, 2, v58
  s_lshl_b32 s100, s7, 3
  s_lshl_b32 s100, 0xff, s100
  s_mov_b32 exec_lo, s100
  s_mov_b32 exec_hi, 0
  ds_write_b32 v58, v61 offset:8256
  s_mov_b64 exec, -1
L_sk_fin:
  s_waitcnt lgkmcnt(0)
  s_barrier
  ds_read_b128 v[144:147], v14 offset:9216
  ds_read_b128 v[148:151], v14 offset:9280
  ds_read_b128 v[56:59], v4 offset:8256
  s_waitcnt lgkmcnt(2)
  v_smfmac_f32_16x16x64_bf16 v[128:131], v[144:147], v[64:71], v2
  s_waitcnt lgkmcnt(1)
  v_smfmac_f32_16x16x64_bf16 v[128:131], v[148:151], v[72:79], v2
  v_smfmac_f32_16x16x64_bf16 v[132:135], v[144:147], v[80:87], v2
  s_waitcnt lgkmcnt(0)
  v_smfmac_f32_16x16x64_bf16 v[132:135], v[148:151], v[88:95], v2
  v_smfmac_f32_16x16x64_bf16 v[136:139], v[144:147], v[96:103], v2
  v_smfmac_f32_16x16x64_bf16 v[136:139], v[148:151], v[104:111], v2
  s_nop 2
  v_fma_f32 v16, v56, v128, v40
  v_fmac_f32 v16, v57, v129
  v_fmac_f32 v16, v58, v130
  v_fmac_f32 v16, v59, v131
  v_smfmac_f32_16x16x64_bf16 v[140:143], v[144:147], v[112:119], v2
  v_fma_f32 v17, v56, v132, v44
  v_fmac_f32 v17, v57, v133
  v_fmac_f32 v17, v58, v134
  v_fmac_f32 v17, v59, v135
  v_smfmac_f32_16x16x64_bf16 v[140:143], v[148:151], v[120:127], v2
  s_nop 0
  v_permlane16_swap_b32 v16, v17
  v_add_f32 v16, v16, v17
  v_fma_f32 v18, v56, v136, v48
  v_fmac_f32 v18, v57, v137
  v_fmac_f32 v18, v58, v138
  v_fmac_f32 v18, v59, v139
  s_nop 0
  v_fma_f32 v19, v56, v140, v52
  v_fmac_f32 v19, v57, v141
  v_fmac_f32 v19, v58, v142
  v_fmac_f32 v19, v59, v143
  s_nop 1
  v_permlane16_swap_b32 v18, v19
  v_add_f32 v18, v18, v19
  s_nop 1
  v_permlane32_swap_b32 v16, v18
  v_add_f32 v16, v16, v18
  v_mul_f32 v20, 0x49000000, v16
  v_cmp_nlt_f32 vcc, |v16|, s13
  v_cmp_le_f32 s[4:5], s12, |v16|
  v_fract_f32 v21, v20
  v_cvt_flr_i32_f32 v23, v20
  v_mul_f32 v21, 0x4f800000, v21
  v_cvt_u32_f32 v21, v21
  v_bfi_b32 v22, v63, 1, v21
  s_cmp_eq_u64 s[4:5], 0
  s_cbranch_scc1 L_side
  s_cbranch_vccnz L_side
  buffer_atomic_add_x2 v[22:23], v7, s[72:75], 0 offen sc0 sc1
  v_cvt_flr_i32_f32 v19, v20
  v_bfi_b32 v18, v63, 1, v21
L_sum:
  s_waitcnt vmcnt(0)
  v_lshl_add_u64 v[18:19], v[22:23], 0, v[18:19]
  v_and_b32 v20, v63, v18
  v_bfi_b32 v18, v63, 0, v18
  v_cmp_eq_u32 vcc, 0x80, v20
  v_cvt_f32_i32 v19, v19
  v_cvt_f32_u32 v18, v18
  v_fmamk_f32 v18, v18, 0x2f800000, v19
  v_fmamk_f32 v16, v18, 0x36000000, v5
  v_cvt_pk_bf16_f32 v17, v16, v16
  s_cbranch_vccz L_nolast
  s_mov_b64 exec, vcc
  buffer_store_short v17, v31, s[80:83], 0 offen
  s_mov_b64 exec, -1
L_nolast:
  v_and_b32 v21, 0xff, v20
  v_cmp_eq_u32 s[4:5], v21, v20
  v_cmp_eq_u32 vcc, 0x80, v21
  s_nop 4
  s_cbranch_vccz L_end
  s_andn2_b64 s[4:5], vcc, s[4:5]
  s_cbranch_scc1 L_sidesum
L_ep:
  s_and_b32 s4, vcc_lo, 1
  s_or_b32 s5, s8, s10
  s_cselect_b32 s4, 0, s4
  s_cmp_eq_u32 s4, 0
  s_cbranch_scc1 L_end
  v_mov_b32 v21, s76
  s_mov_b64 exec, 1
  s_mov_b32 s100, 0
  buffer_store_dword v21, off, s[72:75], s100 sc1
L_end:
  s_endpgm
L_pro:
  s_mov_b32 s98, 0x5f0d5fdf
  s_bfm_b32 s99, s6, 0
  s_and_b32 s99, s99, s98
  s_bcnt1_i32_b32 s14, s99
  s_bitcmp1_b32 s98, s6
  s_cselect_b32 s79, 1, 0
  s_cselect_b32 s14, s14, 0
  s_mov_b32 s15, s7
  s_mul_i32 s97, s15, 352256
  s_lshl_b32 s4, s14, 7
  s_add_u32 s97, s97, s4
  s_mul_i32 s4, s8, 2752
  s_add_u32 s97, s97, s4
  s_sub_u32 s101, 1409024, s97
  s_mul_i32 s101, s101, s79
  v_lshl_add_u32 v7, v3, 1, v5
  v_mul_u32_u24 v7, 2752, v7
  v_lshl_add_u32 v7, v6, 4, v7
  s_cmp_eq_u32 s14, 21
  s_cselect_b32 s4, 4, 0
  v_and_b32 v32, s4, v6
  v_lshl_add_u32 v7, v32, 28, v7
  s_add_u32 s60, s28, s97
  s_addc_u32 s61, s29, 0
  s_mov_b32 s62, s101
  s_mov_b32 s63, 0x20000
  s_add_u32 s64, s30, s97
  s_addc_u32 s65, s31, 0
  s_mov_b32 s66, s101
  s_mov_b32 s67, 0x20000
  s_mov_b32 s4, 11008
  buffer_load_dwordx4 v[80:83], v7, s[60:63], 0 offen nt
  buffer_load_dwordx4 v[84:87], v7, s[60:63], s4 offen nt
  buffer_load_dwordx4 v[88:91], v7, s[64:67], 0 offen nt
  buffer_load_dwordx4 v[92:95], v7, s[64:67], s4 offen nt
  s_lshl_b32 s4, s7, 8
  v_lshl_add_u32 v13, v5, 1, s4
  s_lshl_b32 s4, s15, 8
  v_lshl_add_u32 v7, v5, 1, s4
  s_mov_b32 s72, s38
  s_mov_b32 s73, s39
  s_mov_b32 s74, 268435456
  s_mov_b32 s75, 0x20000
  v_and_b32 v32, 1, v0
  v_lshlrev_b32 v32, 4, v32
  v_mov_b32 v33, 0xffff
  v_lshlrev_b32 v33, v32, v33
  v_bfe_u32 v35, v0, 1, 2
  v_cmp_eq_u32 vcc, 0, v35
  s_nop 1
  v_cndmask_b32 v128, 0, v33, vcc
  v_cmp_eq_u32 vcc, 1, v35
  s_nop 1
  v_cndmask_b32 v129, 0, v33, vcc
  v_cmp_eq_u32 vcc, 2, v35
  s_nop 1
  v_cndmask_b32 v130, 0, v33, vcc
  v_cmp_eq_u32 vcc, 3, v35
  s_nop 1
  v_cndmask_b32 v131, 0, v33, vcc
  s_mov_b32 vcc_lo, 0xff00ff00
  s_mov_b32 vcc_hi, 0xff00ff00
  v_mov_b32 v32, 0x1000c0c
  v_mov_b32 v33, 0x3020c0c
  v_cndmask_b32 v96, v32, v33, vcc
  v_cndmask_b32 v97, v33, v32, vcc
  s_lshl_b32 s4, s9, 10
  v_xor_b32 v32, v3, v10
  v_lshl_add_u32 v102, v6, 4, s4
  v_lshl_add_u32 v102, v11, 7, v102
  v_lshl_add_u32 v102, v32, 8, v102
  v_lshl_add_u32 v102, v10, 9, v102
  s_lshl_b32 s4, s6, 3
  s_add_u32 s4, s4, s12
  s_lshl_b32 s4, s4, 9
  s_add_u32 s4, s4, 131072
  v_and_b32 v32, 15, v0
  v_lshl_add_u32 v100, v32, 3, s4
  v_lshl_add_u32 v100, v10, 7, v100
  v_lshl_add_u32 v100, v11, 8, v100
  v_mov_b32 v104, 0
  v_mov_b32 v105, 1
  v_lshlrev_b32 v106, 4, v0
  s_waitcnt vmcnt(12)
  ds_write_b128 v14, v[40:43] offset:9216
  ds_write_b128 v14, v[44:47] offset:9232
  ds_read_b128 v[48:51], v13 offset:9216
  ds_read_b128 v[52:55], v13 offset:10240
  ds_read_b128 v[56:59], v7 offset:9216
  ds_read_b128 v[60:63], v7 offset:10240
  v_lshlrev_b32 v16, 16, v40
  v_and_b32 v17, 0xffff0000, v40
  v_lshlrev_b32 v18, 16, v41
  v_and_b32 v19, 0xffff0000, v41
  v_lshlrev_b32 v20, 16, v42
  v_and_b32 v21, 0xffff0000, v42
  v_lshlrev_b32 v22, 16, v43
  v_and_b32 v23, 0xffff0000, v43
  v_lshlrev_b32 v24, 16, v44
  v_and_b32 v25, 0xffff0000, v44
  v_lshlrev_b32 v26, 16, v45
  v_and_b32 v27, 0xffff0000, v45
  v_lshlrev_b32 v28, 16, v46
  v_and_b32 v29, 0xffff0000, v46
  v_lshlrev_b32 v30, 16, v47
  v_and_b32 v31, 0xffff0000, v47
  v_add_f32 v32, v16, v17
  v_add_f32 v33, v18, v19
  v_add_f32 v34, v20, v21
  v_add_f32 v35, v22, v23
  v_add_f32 v36, v24, v25
  v_add_f32 v37, v26, v27
  v_add_f32 v38, v28, v29
  v_add_f32 v39, v30, v31
  v_add_f32 v32, v32, v36
  v_add_f32 v33, v33, v37
  v_add_f32 v34, v34, v38
  v_add_f32 v35, v35, v39
  v_add_f32 v32, v32, v34
  v_add_f32 v33, v33, v35
  v_add_f32 v32, v32, v33
  s_nop 1
  v_add_f32_dpp v32, v32, v32 row_ror:8 row_mask:0xf bank_mask:0xf
  s_nop 1
  v_add_f32_dpp v32, v32, v32 row_ror:4 row_mask:0xf bank_mask:0xf
  s_nop 1
  v_add_f32_dpp v32, v32, v32 row_ror:2 row_mask:0xf bank_mask:0xf
  s_nop 1
  v_add_f32_dpp v32, v32, v32 row_ror:1 row_mask:0xf bank_mask:0xf
  v_mov_b32 v33, v32
  s_nop 1
  v_permlane16_swap_b32 v32, v33
  v_add_f32 v32, v32, v33
  v_mul_f32 v32, 0x3b000000, v32
  v_sub_f32 v16, v16, v32
  v_sub_f32 v17, v17, v32
  v_sub_f32 v18, v18, v32
  v_sub_f32 v19, v19, v32
  v_sub_f32 v20, v20, v32
  v_sub_f32 v21, v21, v32
  v_sub_f32 v22, v22, v32
  v_sub_f32 v23, v23, v32
  v_sub_f32 v24, v24, v32
  v_sub_f32 v25, v25, v32
  v_sub_f32 v26, v26, v32
  v_sub_f32 v27, v27, v32
  v_sub_f32 v28, v28, v32
  v_sub_f32 v29, v29, v32
  v_sub_f32 v30, v30, v32
  v_sub_f32 v31, v31, v32
  v_mul_f32 v34, v16, v16
  v_mul_f32 v35, v17, v17
  v_fmac_f32 v34, v18, v18
  v_fmac_f32 v35, v19, v19
  v_fmac_f32 v34, v20, v20
  v_fmac_f32 v35, v21, v21
  v_fmac_f32 v34, v22, v22
  v_fmac_f32 v35, v23, v23
  v_fmac_f32 v34, v24, v24
  v_fmac_f32 v35, v25, v25
  v_fmac_f32 v34, v26, v26
  v_fmac_f32 v35, v27, v27
  v_fmac_f32 v34, v28, v28
  v_fmac_f32 v35, v29, v29
  v_fmac_f32 v34, v30, v30
  v_fmac_f32 v35, v31, v31
  v_add_f32 v34, v34, v35
  v_cvt_pk_bf16_f32 v32, v32, v32
  v_and_b32 v32, 0xffff0000, v32
  s_waitcnt lgkmcnt(0)
  s_add_u32 s76, s77, 1
  s_and_b32 s76, s76, 0xffff
  v_add_f32_dpp v34, v34, v34 row_ror:8 row_mask:0xf bank_mask:0xf
  v_mov_b32 v33, v32
  v_perm_b32 v40, v48, v48, v96
  v_add_f32_dpp v34, v34, v34 row_ror:4 row_mask:0xf bank_mask:0xf
  v_perm_b32 v41, v49, v49, v96
  v_permlane32_swap_b32 v32, v33
  v_add_f32_dpp v34, v34, v34 row_ror:2 row_mask:0xf bank_mask:0xf
  v_perm_b32 v42, v50, v50, v96
  v_perm_b32 v43, v51, v51, v96
  v_add_f32_dpp v34, v34, v34 row_ror:1 row_mask:0xf bank_mask:0xf
  v_perm_b32 v44, v52, v52, v97
  v_perm_b32 v45, v53, v53, v97
  v_mov_b32 v35, v34
  v_perm_b32 v46, v54, v54, v97
  v_perm_b32 v47, v55, v55, v97
  v_permlane16_swap_b32 v34, v35
  v_sub_f32 v40, v40, v32
  v_add_f32 v34, v34, v35
  v_sub_f32 v41, v41, v32
  v_mul_f32 v34, 0x3b000000, v34
  v_sub_f32 v42, v42, v32
  v_cvt_pk_bf16_f32 v34, v34, v34
  v_sub_f32 v43, v43, v32
  v_and_b32 v34, 0xffff0000, v34
  v_sub_f32 v44, v44, v33
  v_add_f32 v34, 0x3727c5ac, v34
  v_sub_f32 v45, v45, v33
  v_cvt_pk_bf16_f32 v34, v34, v34
  v_sub_f32 v46, v46, v33
  v_and_b32 v34, 0xffff0000, v34
  v_sub_f32 v47, v47, v33
  v_sqrt_f32 v34, v34
  v_cvt_pk_bf16_f32 v36, v40, v41
  v_cvt_pk_bf16_f32 v37, v42, v43
  v_cvt_pk_bf16_f32 v34, v34, v34
  v_cvt_pk_bf16_f32 v38, v44, v45
  v_cvt_pk_bf16_f32 v39, v46, v47
  v_and_b32 v34, 0xffff0000, v34
  v_lshlrev_b32 v40, 16, v36
  v_and_b32 v41, 0xffff0000, v36
  v_rcp_f32 v34, v34
  v_lshlrev_b32 v42, 16, v37
  v_and_b32 v43, 0xffff0000, v37
  v_mov_b32 v35, v34
  v_lshlrev_b32 v44, 16, v38
  v_and_b32 v45, 0xffff0000, v38
  v_permlane32_swap_b32 v34, v35
  v_lshlrev_b32 v46, 16, v39
  v_and_b32 v47, 0xffff0000, v39
  s_or_b32 s4, s76, 0x10000
  v_mov_b32 v107, s4
  ds_write_b32 v104, v107 offset:8208
  v_mul_f32 v40, v40, v34
  v_mul_f32 v41, v41, v34
  v_mul_f32 v42, v42, v34
  v_mul_f32 v43, v43, v34
  v_mul_f32 v44, v44, v35
  v_mul_f32 v45, v45, v35
  v_mul_f32 v46, v46, v35
  v_mul_f32 v47, v47, v35
  v_cvt_pk_bf16_f32 v40, v40, v40
  v_cvt_pk_bf16_f32 v41, v41, v41
  v_cvt_pk_bf16_f32 v42, v42, v42
  v_cvt_pk_bf16_f32 v43, v43, v43
  v_cvt_pk_bf16_f32 v44, v44, v44
  v_cvt_pk_bf16_f32 v45, v45, v45
  v_cvt_pk_bf16_f32 v46, v46, v46
  v_cvt_pk_bf16_f32 v47, v47, v47
  v_and_b32 v132, v40, v128
  v_and_b32 v133, v40, v129
  v_and_b32 v134, v40, v130
  v_and_b32 v135, v40, v131
  v_and_b32 v136, v44, v128
  v_and_b32 v137, v44, v129
  v_and_b32 v138, v44, v130
  v_and_b32 v139, v44, v131
  v_and_b32 v140, v41, v128
  v_and_b32 v141, v41, v129
  v_and_b32 v142, v41, v130
  v_and_b32 v143, v41, v131
  v_and_b32 v144, v45, v128
  v_and_b32 v145, v45, v129
  v_and_b32 v146, v45, v130
  v_and_b32 v147, v45, v131
  s_waitcnt vmcnt(11)
  v_mfma_f32_16x16x32_bf16 v[16:19], v[64:67], v[132:135], 0
  v_mfma_f32_16x16x32_bf16 v[20:23], v[64:67], v[136:139], 0
  v_and_b32 v148, v42, v128
  v_and_b32 v149, v42, v129
  v_and_b32 v150, v42, v130
  v_and_b32 v151, v42, v131
  v_and_b32 v152, v46, v128
  v_and_b32 v153, v46, v129
  v_and_b32 v154, v46, v130
  v_and_b32 v155, v46, v131
  s_waitcnt vmcnt(10)
  v_mfma_f32_16x16x32_bf16 v[16:19], v[68:71], v[140:143], v[16:19]
  v_mfma_f32_16x16x32_bf16 v[20:23], v[68:71], v[144:147], v[20:23]
  v_and_b32 v156, v43, v128
  v_and_b32 v157, v43, v129
  v_and_b32 v158, v43, v130
  v_and_b32 v159, v43, v131
  v_and_b32 v160, v47, v128
  v_and_b32 v161, v47, v129
  v_and_b32 v162, v47, v130
  v_and_b32 v163, v47, v131
  s_waitcnt vmcnt(9)
  v_mfma_f32_16x16x32_bf16 v[16:19], v[72:75], v[148:151], v[16:19]
  v_mfma_f32_16x16x32_bf16 v[20:23], v[72:75], v[152:155], v[20:23]
  s_waitcnt vmcnt(8)
  v_mfma_f32_16x16x32_bf16 v[16:19], v[76:79], v[156:159], v[16:19]
  v_mfma_f32_16x16x32_bf16 v[20:23], v[76:79], v[160:163], v[20:23]
  s_mov_b32 vcc_lo, 0xff00ff00
  s_mov_b32 vcc_hi, 0xff00ff
  s_nop 5
  v_cndmask_b32 v16, v16, v20, vcc
  v_cndmask_b32 v17, v17, v21, vcc
  v_cndmask_b32 v18, v18, v22, vcc
  v_cndmask_b32 v19, v19, v23, vcc
  ds_write_b128 v102, v[16:19] offset:0
  s_waitcnt lgkmcnt(0)
  s_mov_b64 exec, 1
  ds_add_rtn_u32 v107, v104, v105 offset:8192
  s_mov_b64 exec, -1
  s_waitcnt lgkmcnt(0)
  v_readfirstlane_b32 s4, v107
  s_nop 0
  s_cmp_eq_u32 s4, 3
  s_cbranch_scc0 L_sk_qp
  ds_read_b128 v[16:19], v106 offset:0
  ds_read_b128 v[20:23], v106 offset:1024
  ds_read_b128 v[24:27], v106 offset:2048
  ds_read_b128 v[28:31], v106 offset:3072
  s_getreg_b32 s4, hwreg(HW_REG_XCC_ID, 0, 4)
  s_cmp_lg_u32 s4, s3
  s_cselect_b32 s4, 4, 0
  s_and_b32 s5, s76, 3
  s_or_b32 s4, s4, s5
  s_waitcnt lgkmcnt(0)
  v_add_f32 v16, v16, v20
  v_add_f32 v17, v17, v21
  v_add_f32 v18, v18, v22
  v_add_f32 v19, v19, v23
  v_add_f32 v24, v24, v28
  v_add_f32 v25, v25, v29
  v_add_f32 v26, v26, v30
  v_add_f32 v27, v27, v31
  v_add_f32 v16, v16, v24
  v_add_f32 v17, v17, v25
  v_add_f32 v18, v18, v26
  v_add_f32 v19, v19, v27
  v_permlane32_swap_b32 v16, v17
  s_nop 0
  v_permlane32_swap_b32 v18, v19
  v_add_f32 v16, v16, v17
  v_add_f32 v17, v18, v19
  v_bfi_b32 v16, 7, s4, v16
  v_bfi_b32 v17, 7, s4, v17
  s_bitcmp1_b32 s4, 2
  s_cbranch_scc1 L_far_pq
  buffer_store_dwordx2 v[16:17], v100, s[72:75], 0 offen
L_back_pq:
L_sk_qp:
  s_cmp_eq_u32 s79, 0
  s_cbranch_scc1 L_burst
  s_mul_i32 s26, s8, 0x02020000
  s_add_u32 s26, s26, 0x1000c0c
  s_mov_b32 s27, 0x04040000
  v_mul_lo_u32 v98, v3, s27
  v_xor_b32 v99, s27, v98
  v_add_u32 v98, s26, v98
  v_add_u32 v99, s26, v99
  s_lshl_b32 s4, s14, 13
  s_lshl_b32 s5, s12, 7
  s_add_u32 s4, s4, s5
  s_add_u32 s4, s4, 262144
  v_lshrrev_b32 v36, 3, v0
  v_lshl_add_u32 v101, v6, 4, s4
  v_lshl_add_u32 v101, v36, 10, v101
  s_lshl_b32 s4, s9, 10
  v_and_b32 v36, 3, v0
  v_lshl_add_u32 v103, v36, 4, s4
  v_lshl_add_u32 v103, v10, 6, v103
  v_lshl_add_u32 v103, v3, 7, v103
  v_bfe_u32 v36, v0, 2, 1
  v_lshl_add_u32 v103, v36, 8, v103
  v_lshl_add_u32 v103, v11, 9, v103
  v_perm_b32 v40, v57, v56, v98
  v_perm_b32 v41, v59, v58, v98
  v_perm_b32 v42, v61, v60, v99
  v_perm_b32 v43, v63, v62, v99
  v_sub_f32 v40, v40, v32
  v_sub_f32 v41, v41, v32
  v_sub_f32 v42, v42, v33
  v_sub_f32 v43, v43, v33
  v_cvt_pk_bf16_f32 v36, v40, v41
  v_cvt_pk_bf16_f32 v37, v42, v43
  v_lshlrev_b32 v40, 16, v36
  v_and_b32 v41, 0xffff0000, v36
  v_lshlrev_b32 v42, 16, v37
  v_and_b32 v43, 0xffff0000, v37
  v_mul_f32 v40, v40, v34
  v_mul_f32 v41, v41, v34
  v_mul_f32 v42, v42, v35
  v_mul_f32 v43, v43, v35
  v_cvt_pk_bf16_f32 v40, v40, v40
  v_cvt_pk_bf16_f32 v41, v41, v41
  v_cvt_pk_bf16_f32 v42, v42, v42
  v_cvt_pk_bf16_f32 v43, v43, v43
  v_and_b32 v164, v40, v128
  v_and_b32 v165, v40, v129
  v_and_b32 v166, v40, v130
  v_and_b32 v167, v40, v131
  v_and_b32 v168, v41, v128
  v_and_b32 v169, v41, v129
  v_and_b32 v170, v41, v130
  v_and_b32 v171, v41, v131
  v_and_b32 v172, v42, v128
  v_and_b32 v173, v42, v129
  v_and_b32 v174, v42, v130
  v_and_b32 v175, v42, v131
  v_and_b32 v176, v43, v128
  v_and_b32 v177, v43, v129
  v_and_b32 v178, v43, v130
  v_and_b32 v179, v43, v131
  s_waitcnt vmcnt(0)
  v_mfma_f32_16x16x32_bf16 v[180:183], v[80:83], v[164:167], 0
  v_mfma_f32_16x16x32_bf16 v[184:187], v[80:83], v[172:175], 0
  v_mfma_f32_16x16x32_bf16 v[188:191], v[88:91], v[164:167], 0
  v_mfma_f32_16x16x32_bf16 v[192:195], v[88:91], v[172:175], 0
  v_mfma_f32_16x16x32_bf16 v[180:183], v[84:87], v[168:171], v[180:183]
  v_mfma_f32_16x16x32_bf16 v[184:187], v[84:87], v[176:179], v[184:187]
  v_mfma_f32_16x16x32_bf16 v[188:191], v[92:95], v[168:171], v[188:191]
  v_mfma_f32_16x16x32_bf16 v[192:195], v[92:95], v[176:179], v[192:195]
  s_mov_b32 vcc_lo, 0xff00ff00
  s_mov_b32 vcc_hi, 0xff00ff
  s_nop 3
  v_cndmask_b32 v180, v180, v184, vcc
  v_cndmask_b32 v181, v181, v185, vcc
  v_cndmask_b32 v182, v182, v186, vcc
  v_cndmask_b32 v183, v183, v187, vcc
  v_cndmask_b32 v188, v188, v192, vcc
  v_cndmask_b32 v189, v189, v193, vcc
  v_cndmask_b32 v190, v190, v194, vcc
  v_cndmask_b32 v191, v191, v195, vcc
  v_permlane32_swap_b32 v180, v188
  v_permlane32_swap_b32 v181, v189
  v_permlane32_swap_b32 v182, v190
  v_permlane32_swap_b32 v183, v191
  v_add_f32_dpp v180, v188, v180 row_ror:8 row_mask:0xf bank_mask:0xf
  v_add_f32_dpp v181, v189, v181 row_ror:8 row_mask:0xf bank_mask:0xf
  v_add_f32_dpp v182, v190, v182 row_ror:8 row_mask:0xf bank_mask:0xf
  v_add_f32_dpp v183, v191, v183 row_ror:8 row_mask:0xf bank_mask:0xf
  ds_write_b128 v103, v[180:183] offset:4096
  s_waitcnt lgkmcnt(0)
  s_mov_b64 exec, 1
  ds_add_rtn_u32 v107, v104, v105 offset:8204
  s_mov_b64 exec, -1
  s_waitcnt lgkmcnt(0)
  v_readfirstlane_b32 s4, v107
  s_nop 0
  s_cmp_lg_u32 s4, 3
  s_cbranch_scc1 L_burst
  ds_read_b128 v[16:19], v106 offset:4096
  ds_read_b128 v[20:23], v106 offset:5120
  ds_read_b128 v[24:27], v106 offset:6144
  ds_read_b128 v[28:31], v106 offset:7168
  s_waitcnt lgkmcnt(0)
  v_add_f32 v16, v16, v20
  v_add_f32 v17, v17, v21
  v_add_f32 v18, v18, v22
  v_add_f32 v19, v19, v23
  v_add_f32 v24, v24, v28
  v_add_f32 v25, v25, v29
  v_add_f32 v26, v26, v30
  v_add_f32 v27, v27, v31
  v_add_f32 v16, v16, v24
  v_add_f32 v17, v17, v25
  v_add_f32 v18, v18, v26
  v_add_f32 v19, v19, v27
  v_bfi_b32 v16, 63, s76, v16
  v_bfi_b32 v17, 63, s76, v17
  v_bfi_b32 v18, 63, s76, v18
  v_bfi_b32 v19, 63, s76, v19
  s_getreg_b32 s4, hwreg(HW_REG_XCC_ID, 0, 4)
  s_cmp_lg_u32 s4, s3
  s_cbranch_scc1 L_far_pf
  buffer_store_dwordx4 v[16:19], v101, s[72:75], 0 offen
L_back_pf:
  s_nop 1
  s_branch L_burst
L_far_pq:
  buffer_store_dwordx2 v[16:17], v100, s[72:75], 0 offen sc1
  s_branch L_back_pq
L_far_pf:
  buffer_store_dwordx4 v[16:19], v101, s[72:75], 0 offen sc1
  s_branch L_back_pf
L_far_q:
  s_getreg_b32 s4, hwreg(HW_REG_XCC_ID, 0, 4)
  s_cmp_lg_u32 s4, s3
  s_cbranch_scc1 L_back_q
  s_waitcnt vmcnt(0)
  buffer_wbl2 sc1
  s_branch L_back_q
L_far_s:
  s_waitcnt vmcnt(0)
  buffer_store_dwordx4 v[60:63], v16, s[72:75], 0 offen sc1
  s_branch L_back_s
L_side:
  v_and_b32 v24, 7, v0
  v_lshlrev_b32 v24, 2, v24
  v_sub_u32 v24, v7, v24
  buffer_atomic_add_f32 v16, v24, s[72:75], 0 offen offset:64 sc0 sc1
  v_mov_b32 v22, 0x101
  v_mov_b32 v23, 0
  v_mov_b32 v18, 0x101
  v_mov_b32 v19, 0
  s_waitcnt vmcnt(0)
  buffer_atomic_add_x2 v[22:23], v7, s[72:75], 0 offen sc0 sc1
  s_branch L_sum
L_sidesum:
  v_and_b32 v24, 7, v0
  v_lshlrev_b32 v24, 2, v24
  v_sub_u32 v24, v7, v24
  v_mov_b32 v22, 0
  s_mov_b64 exec, s[4:5]
  buffer_atomic_add_f32 v22, v24, s[72:75], 0 offen offset:64 sc0 sc1
  s_waitcnt vmcnt(0)
  v_fmamk_f32 v22, v18, 0x36000000, v22
  v_add_f32 v16, v22, v5
  v_cvt_pk_bf16_f32 v17, v16, v16
  buffer_store_short v17, v31, s[80:83], 0 offen
  s_mov_b64 exec, -1
  s_branch L_ep
.section .rodata,"a"
.p2align 6
.amdhsa_kernel parallel_sum__mha_block_cached__geglu_ffn__decode_kernel
  .amdhsa_next_free_vgpr 256
  .amdhsa_next_free_sgpr 102
  .amdhsa_accum_offset 256
  .amdhsa_group_segment_fixed_size 0
  .amdhsa_kernarg_size 96
  .amdhsa_user_sgpr_count 2
  .amdhsa_user_sgpr_kernarg_segment_ptr 1
  .amdhsa_system_sgpr_workgroup_id_x 1
  .amdhsa_float_denorm_mode_32 3
.end_amdhsa_kernel
```
